```python
import torch

def _softmax(x, axis=-1):
    return torch.softmax(x, dim=axis)

def _gelu(x):
    return torch.nn.functional.gelu(x, approximate='tanh')

def _silu(x):
    return torch.nn.functional.silu(x)

def _sigmoid(x):
    return torch.sigmoid(x)

def _layernorm(x, axis=-1, eps=1e-05):
    m = x.mean(dim=axis, keepdim=True)
    v = x.var(dim=axis, keepdim=True, unbiased=False)
    return (x - m) / torch.sqrt(v + eps)

def _scatter_add(tgt, idx, src, axis=0):
    return tgt.clone().index_add_(axis, idx, src)

def _segment_sum(src, seg, n):
    out = torch.zeros((n,) + src.shape[1:], dtype=src.dtype)
    return out.index_add_(0, seg, src)

def _pad(x, pw):
    flat = tuple((v for pair in reversed(pw) for v in pair))
    return torch.nn.functional.pad(x, flat)
kernel_name = 'adaLN_cond__mha_block_cached__swiglu_ffn__decode'

def setup_inputs():

    _w = lambda a: (lambda t: t.to(torch.bfloat16) if t.is_floating_point() else t)(torch.as_tensor(a))

    def _A_setup():
        B, Sq, D = (1, 1, 576)
        H, Sk, Dh = (32, 8192, 128)
        return {'x': _w((lambda *s: torch.randn(*s, dtype=torch.bfloat16) * 0.05)(B, Sq, D)), 'k_cache': _w((lambda *s: torch.randn(*s, dtype=torch.bfloat16) * 3.2)(B, H, Sk, Dh)), 'v_cache': _w((lambda *s: torch.randn(*s, dtype=torch.bfloat16) * 0.4)(B, H, Sk, Dh)), 'wq': _w((lambda *s: torch.randn(*s, dtype=torch.bfloat16) * 3.2)(D, H * Dh) * D ** (-0.5)), 'wo': _w((lambda *s: torch.randn(*s, dtype=torch.bfloat16) * 0.4)(H * Dh, D) * (H * Dh) ** (-0.5))}
    _A_in = _A_setup()

    def _B_setup():
        B, S, D, F = (1, 1, 576, 4608)
        return {'x': _w((lambda *s: torch.randn(*s, dtype=torch.bfloat16) * 0.05)(B, S, D)), 'w_gate': _w((lambda *s: torch.randn(*s, dtype=torch.bfloat16) * 0.05)(D, F)), 'w_up': _w((lambda *s: torch.randn(*s, dtype=torch.bfloat16) * 0.05)(D, F)), 'w_down': _w((lambda *s: torch.randn(*s, dtype=torch.bfloat16) * 0.05)(F, D))}
    _B_in = _B_setup()
    return {'A_x': _A_in['x'], 'A_k_cache': _A_in['k_cache'], 'A_v_cache': _A_in['v_cache'], 'A_wq': _A_in['wq'], 'A_wo': _A_in['wo'], 'B_x': _B_in['x'], 'B_w_gate': _B_in['w_gate'], 'B_w_up': _B_in['w_up'], 'B_w_down': _B_in['w_down'], 'c': _w((lambda *s: torch.randn(*s, dtype=torch.bfloat16) * 0.1)(1, 576) * 8.0), 'w_mod': _w((lambda *s: torch.randn(*s, dtype=torch.bfloat16) * 0.1)(576, 6 * 576) * 576 ** (-0.5) * 8.0)}

def reference(A_x, A_k_cache, A_v_cache, A_wq, A_wo, B_x, B_w_gate, B_w_up, B_w_down, c, w_mod):

    def _A_ref(x, k_cache, v_cache, wq, wo):
        B, Sq, D = x.shape
        H, Dh = (32, 128)
        q = (lambda x, *d: x.permute(*d))((x @ wq).reshape(B, Sq, H, Dh), 0, 2, 1, 3)
        scores = torch.einsum('bhqd,bhkd->bhqk', q, k_cache) * Dh ** (-0.5)
        p = _softmax(scores, axis=-1)
        o = torch.einsum('bhqk,bhkd->bhqd', p, v_cache)
        return (lambda x, *d: x.permute(*d))(o, 0, 2, 1, 3).reshape(B, Sq, H * Dh) @ wo

    def _B_ref(x, w_gate, w_up, w_down):
        g = _silu(x @ w_gate)
        u = x @ w_up
        return g * u @ w_down
    x = A_x
    mod = (_silu(c) @ w_mod).reshape(c.shape[0], 6, 1, -1)
    sa, ca, ga, sb, cb, gb = (mod[:, 0].clone(), mod[:, 1].clone(), mod[:, 2].clone(), mod[:, 3].clone(), mod[:, 4].clone(), mod[:, 5].clone())
    h = _layernorm(x, axis=-1) * (1 + ca) + sa
    x = x + ga * _A_ref(h, A_k_cache, A_v_cache, A_wq, A_wo)
    h = _layernorm(x, axis=-1) * (1 + cb) + sb
    x = x + gb * _B_ref(h, B_w_gate, B_w_up, B_w_down)
    return x
```

```asm
; @launch grid=(256,1,1) block=(768,1,1) lds=163840
.amdgcn_target "amdgcn-amd-amdhsa--gfx950"
.text
.globl adaLN_cond__mha_block_cached__swiglu_ffn__decode_kernel
.p2align 8
.type adaLN_cond__mha_block_cached__swiglu_ffn__decode_kernel,@function
adaLN_cond__mha_block_cached__swiglu_ffn__decode_kernel:
    s_cmp_ge_u32 s2, 256
    s_cbranch_scc1 L_end
    s_load_dwordx16 s[16:31], s[0:1], 0
    s_load_dwordx8 s[32:39], s[0:1], 64
    s_load_dwordx4 s[40:43], s[0:1], 96
    v_lshrrev_b32 v1, 6, v0
    v_and_b32 v0, 63, v0
    v_readfirstlane_b32 s3, v1
    s_and_b32 s4, s2, 7
    s_lshr_b32 s5, s2, 3
    s_lshl_b32 s6, s4, 5
    s_add_u32 s6, s6, s5
    s_lshr_b32 s7, s6, 3
    s_and_b32 s8, s6, 7
    s_mul_i32 s10, s4, 18
    s_add_u32 s10, s10, s5
    s_mov_b32 s59, 30000
    s_cmp_lt_u32 s3, 4
    s_cbranch_scc1 L_service
    s_sub_u32 s3, s3, 4
    s_setprio 1
    v_bfe_u32 v1, v0, 2, 2
    v_lshlrev_b32 v1, 8, v1
    v_lshrrev_b32 v3, 4, v0
    v_lshl_add_u32 v1, v3, 6, v1
    v_and_b32 v2, 3, v0
    v_lshl_add_u32 v1, v2, 4, v1
    v_and_b32 v2, 15, v0
    v_lshlrev_b32 v2, 4, v2
    v_lshl_add_u32 v2, v3, 10, v2
    s_lshl_b32 s11, s6, 18
    s_lshl_b32 s12, s3, 12
    s_add_u32 s11, s11, s12
    v_mov_b32 v6, 0
    s_waitcnt lgkmcnt(0)
    s_add_u32 s44, s18, s11
    s_addc_u32 s45, s19, 0
    s_add_u32 s46, s20, s11
    s_addc_u32 s47, s21, 0
    s_load_dword s58, s[42:43], 245760
    s_add_u32 s98, s42, 33554432
    s_addc_u32 s99, s43, 0
    s_mov_b64 s[96:97], s[42:43]
    s_cmp_lt_u32 s5, 18
    s_cselect_b64 s[50:51], -1, 0
    s_mov_b64 vcc, s[50:51]
    s_sub_u32 s9, s2, 216
    s_cmp_lt_u32 s9, 18
    s_cselect_b64 vcc, -1, 0
    s_barrier
    global_load_dwordx4 v[40:43], v1, s[44:45] offset:0 nt
    global_load_dwordx4 v[44:47], v1, s[44:45] offset:1024 nt
    global_load_dwordx4 v[48:51], v1, s[44:45] offset:2048 nt
    s_cbranch_vccnz Lt_1
    s_waitcnt vmcnt(2)
Lt_1:
    global_load_dwordx4 v[52:55], v1, s[44:45] offset:3072 nt
    s_add_u32 s44, s44, 0x8000
    s_addc_u32 s45, s45, 0
    s_cbranch_vccnz Lt_2
    s_waitcnt vmcnt(2)
Lt_2:
    s_waitcnt vmcnt(3)
    global_load_dwordx4 v[56:59], v1, s[44:45] offset:0 nt
    s_cbranch_vccnz Lt_3
    s_waitcnt vmcnt(2)
Lt_3:
    s_waitcnt vmcnt(3)
    global_load_dwordx4 v[60:63], v1, s[44:45] offset:1024 nt
    s_cbranch_vccnz Lt_4
    s_waitcnt vmcnt(2)
Lt_4:
    s_waitcnt vmcnt(3)
    global_load_dwordx4 v[64:67], v1, s[44:45] offset:2048 nt
    s_cbranch_vccnz Lt_5
    s_waitcnt vmcnt(2)
Lt_5:
    s_waitcnt vmcnt(3)
    global_load_dwordx4 v[68:71], v1, s[44:45] offset:3072 nt
    s_add_u32 s44, s44, 0x8000
    s_addc_u32 s45, s45, 0
    s_cbranch_vccnz Lt_6
    s_waitcnt vmcnt(2)
Lt_6:
    s_waitcnt vmcnt(3)
    global_load_dwordx4 v[72:75], v1, s[44:45] offset:0 nt
    s_cbranch_vccnz Lt_7
    s_waitcnt vmcnt(2)
Lt_7:
    s_waitcnt vmcnt(3)
    global_load_dwordx4 v[76:79], v1, s[44:45] offset:1024 nt
    s_cbranch_vccnz Lt_8
    s_waitcnt vmcnt(2)
Lt_8:
    s_waitcnt vmcnt(3)
    global_load_dwordx4 v[80:83], v1, s[44:45] offset:2048 nt
    s_cbranch_vccnz Lt_9
    s_waitcnt vmcnt(2)
Lt_9:
    s_waitcnt vmcnt(3)
    global_load_dwordx4 v[84:87], v1, s[44:45] offset:3072 nt
    s_add_u32 s44, s44, 0x8000
    s_addc_u32 s45, s45, 0
    s_cbranch_vccnz Lt_10
    s_waitcnt vmcnt(2)
Lt_10:
    s_waitcnt vmcnt(3)
    global_load_dwordx4 v[88:91], v1, s[44:45] offset:0 nt
    s_cbranch_vccnz Lt_11
    s_waitcnt vmcnt(2)
Lt_11:
    s_waitcnt vmcnt(3)
    global_load_dwordx4 v[92:95], v1, s[44:45] offset:1024 nt
    s_cbranch_vccnz Lt_12
    s_waitcnt vmcnt(2)
Lt_12:
    s_waitcnt vmcnt(3)
    global_load_dwordx4 v[96:99], v1, s[44:45] offset:2048 nt
    s_cbranch_vccnz Lt_13
    s_waitcnt vmcnt(2)
Lt_13:
    s_waitcnt vmcnt(3)
    global_load_dwordx4 v[100:103], v1, s[44:45] offset:3072 nt
    s_add_u32 s44, s44, 0x8000
    s_addc_u32 s45, s45, 0
    s_cbranch_vccnz Lt_14
    s_waitcnt vmcnt(2)
Lt_14:
    s_waitcnt vmcnt(3)
    global_load_dwordx4 v[104:107], v1, s[44:45] offset:0 nt
    s_cbranch_vccnz Lt_15
    s_waitcnt vmcnt(2)
Lt_15:
    s_waitcnt vmcnt(3)
    global_load_dwordx4 v[108:111], v1, s[44:45] offset:1024 nt
    s_cbranch_vccnz Lt_16
    s_waitcnt vmcnt(2)
Lt_16:
    s_waitcnt vmcnt(3)
    global_load_dwordx4 v[112:115], v1, s[44:45] offset:2048 nt
    s_cbranch_vccnz Lt_17
    s_waitcnt vmcnt(2)
Lt_17:
    s_waitcnt vmcnt(3)
    global_load_dwordx4 v[116:119], v1, s[44:45] offset:3072 nt
    s_add_u32 s44, s44, 0x8000
    s_addc_u32 s45, s45, 0
    s_cbranch_vccnz Lt_18
    s_waitcnt vmcnt(2)
Lt_18:
    s_waitcnt vmcnt(3)
    global_load_dwordx4 v[120:123], v1, s[44:45] offset:0 nt
    s_cbranch_vccnz Lt_19
    s_waitcnt vmcnt(2)
Lt_19:
    s_waitcnt vmcnt(3)
    global_load_dwordx4 v[124:127], v1, s[44:45] offset:1024 nt
    s_cbranch_vccnz Lt_20
    s_waitcnt vmcnt(2)
Lt_20:
    s_waitcnt vmcnt(3)
    global_load_dwordx4 v[128:131], v1, s[44:45] offset:2048 nt
    s_cbranch_vccnz Lt_21
    s_waitcnt vmcnt(2)
Lt_21:
    s_waitcnt vmcnt(3)
    global_load_dwordx4 v[132:135], v1, s[44:45] offset:3072 nt
    s_add_u32 s44, s44, 0x8000
    s_addc_u32 s45, s45, 0
    s_cbranch_vccnz Lt_22
    s_waitcnt vmcnt(2)
Lt_22:
    s_waitcnt vmcnt(3)
    global_load_dwordx4 v[136:139], v1, s[44:45] offset:0 nt
    s_cbranch_vccnz Lt_23
    s_waitcnt vmcnt(2)
Lt_23:
    s_waitcnt vmcnt(3)
    global_load_dwordx4 v[140:143], v1, s[44:45] offset:1024 nt
    s_cbranch_vccnz Lt_24
    s_waitcnt vmcnt(2)
Lt_24:
    s_waitcnt vmcnt(3)
    global_load_dwordx4 v[144:147], v1, s[44:45] offset:2048 nt
    s_cbranch_vccnz Lt_25
    s_waitcnt vmcnt(2)
Lt_25:
    s_waitcnt vmcnt(3)
    global_load_dwordx4 v[148:151], v1, s[44:45] offset:3072 nt
    s_add_u32 s44, s44, 0x8000
    s_addc_u32 s45, s45, 0
    s_cbranch_vccnz Lt_26
    s_waitcnt vmcnt(2)
Lt_26:
    s_waitcnt vmcnt(3)
    global_load_dwordx4 v[152:155], v1, s[44:45] offset:0 nt
    s_cbranch_vccnz Lt_27
    s_waitcnt vmcnt(2)
Lt_27:
    s_waitcnt vmcnt(3)
    global_load_dwordx4 v[156:159], v1, s[44:45] offset:1024 nt
    s_cbranch_vccnz Lt_28
    s_waitcnt vmcnt(2)
Lt_28:
    s_waitcnt vmcnt(3)
    global_load_dwordx4 v[160:163], v1, s[44:45] offset:2048 nt
    s_cbranch_vccnz Lt_29
    s_waitcnt vmcnt(2)
Lt_29:
    s_waitcnt vmcnt(3)
    global_load_dwordx4 v[164:167], v1, s[44:45] offset:3072 nt
    s_lshl_b32 s13, s3, 14
    s_add_u32 s13, s13, 32768
    s_mov_b32 s14, 2
    v_lshrrev_b32 v3, 4, v0
    v_lshlrev_b32 v3, 6, v3
    v_and_b32 v32, 3, v0
    v_lshl_add_u32 v3, v32, 4, v3
    v_bfe_u32 v32, v0, 2, 2
    s_setprio 0
    s_add_u32 m0, s13, 0
    s_cbranch_vccnz Lt_30
    s_waitcnt vmcnt(2)
Lt_30:
    s_waitcnt vmcnt(3)
    global_load_lds_dwordx4 v2, s[46:47] offset:0 nt
    s_add_u32 m0, s13, 768
    s_cbranch_vccnz Lt_31
    s_waitcnt vmcnt(2)
Lt_31:
    s_waitcnt vmcnt(3)
    global_load_lds_dwordx4 v2, s[46:47] offset:256 nt
    s_add_u32 m0, s13, 1536
    s_cbranch_vccnz Lt_32
    s_waitcnt vmcnt(2)
Lt_32:
    s_waitcnt vmcnt(3)
    global_load_lds_dwordx4 v2, s[46:47] offset:512 nt
    s_add_u32 m0, s13, 2304
    s_cbranch_vccnz Lt_33
    s_waitcnt vmcnt(2)
Lt_33:
    s_waitcnt vmcnt(3)
    global_load_lds_dwordx4 v2, s[46:47] offset:768 nt
    s_add_u32 s46, s46, 0x8000
    s_addc_u32 s47, s47, 0
    s_add_u32 m0, s13, 4096
    s_cbranch_vccnz Lt_34
    s_waitcnt vmcnt(2)
Lt_34:
    s_waitcnt vmcnt(3)
    global_load_lds_dwordx4 v2, s[46:47] offset:0 nt
    s_add_u32 m0, s13, 4864
    s_cbranch_vccnz Lt_35
    s_waitcnt vmcnt(2)
Lt_35:
    s_waitcnt vmcnt(3)
    global_load_lds_dwordx4 v2, s[46:47] offset:256 nt
    s_add_u32 m0, s13, 5632
    s_cbranch_vccnz Lt_36
    s_waitcnt vmcnt(2)
Lt_36:
    s_waitcnt vmcnt(3)
    global_load_lds_dwordx4 v2, s[46:47] offset:512 nt
    s_add_u32 m0, s13, 6400
    s_cbranch_vccnz Lt_37
    s_waitcnt vmcnt(2)
Lt_37:
    s_waitcnt vmcnt(3)
    global_load_lds_dwordx4 v2, s[46:47] offset:768 nt
    s_add_u32 s46, s46, 0x8000
    s_addc_u32 s47, s47, 0
    ds_read_b32 v33, v6 offset:12
    s_waitcnt lgkmcnt(0)
    v_readfirstlane_b32 s9, v33
    s_nop 0
    s_cmp_ge_u32 s9, 1
    s_cbranch_scc1 L_kc
    s_add_u32 m0, s13, 8192
    s_cbranch_vccnz Lt_38
    s_waitcnt vmcnt(2)
Lt_38:
    s_waitcnt vmcnt(3)
    global_load_lds_dwordx4 v2, s[46:47] offset:0 nt
    s_add_u32 m0, s13, 8960
    s_cbranch_vccnz Lt_39
    s_waitcnt vmcnt(2)
Lt_39:
    s_waitcnt vmcnt(3)
    global_load_lds_dwordx4 v2, s[46:47] offset:256 nt
    s_add_u32 m0, s13, 9728
    s_cbranch_vccnz Lt_40
    s_waitcnt vmcnt(2)
Lt_40:
    s_waitcnt vmcnt(3)
    global_load_lds_dwordx4 v2, s[46:47] offset:512 nt
    s_add_u32 m0, s13, 10496
    s_cbranch_vccnz Lt_41
    s_waitcnt vmcnt(2)
Lt_41:
    s_waitcnt vmcnt(3)
    global_load_lds_dwordx4 v2, s[46:47] offset:768 nt
    s_add_u32 s46, s46, 0x8000
    s_addc_u32 s47, s47, 0
    s_mov_b32 s14, 3
    ds_read_b32 v33, v6 offset:12
    s_waitcnt lgkmcnt(0)
    v_readfirstlane_b32 s9, v33
    s_nop 0
    s_cmp_ge_u32 s9, 1
    s_cbranch_scc1 L_kc
    s_add_u32 m0, s13, 12288
    s_cbranch_vccnz Lt_42
    s_waitcnt vmcnt(2)
Lt_42:
    s_waitcnt vmcnt(3)
    global_load_lds_dwordx4 v2, s[46:47] offset:0 nt
    s_add_u32 m0, s13, 13056
    s_cbranch_vccnz Lt_43
    s_waitcnt vmcnt(2)
Lt_43:
    s_waitcnt vmcnt(3)
    global_load_lds_dwordx4 v2, s[46:47] offset:256 nt
    s_add_u32 m0, s13, 13824
    s_cbranch_vccnz Lt_44
    s_waitcnt vmcnt(2)
Lt_44:
    s_waitcnt vmcnt(3)
    global_load_lds_dwordx4 v2, s[46:47] offset:512 nt
    s_add_u32 m0, s13, 14592
    s_cbranch_vccnz Lt_45
    s_waitcnt vmcnt(2)
Lt_45:
    s_waitcnt vmcnt(3)
    global_load_lds_dwordx4 v2, s[46:47] offset:768 nt
    s_add_u32 s46, s46, 0x8000
    s_addc_u32 s47, s47, 0
    s_mov_b32 s14, 4
    s_mov_b32 s60, 300000
Lspin_46:
    ds_read_b32 v33, v6 offset:12
    s_waitcnt lgkmcnt(0)
    v_readfirstlane_b32 s9, v33
    s_nop 0
    s_cmp_ge_u32 s9, 1
    s_cbranch_scc1 Lsdone_47
    s_sub_u32 s60, s60, 1
    s_cbranch_scc1 Lsdone_47
    s_sleep 2
    s_branch Lspin_46
Lsdone_47:
L_kc:
    s_setprio 1
    ds_read_b128 v[4:7], v3 offset:256
    s_waitcnt lgkmcnt(0)
    v_cmp_eq_u32 vcc, 0, v32
    s_nop 1
    v_cndmask_b32 v8, 0, v4, vcc
    v_cndmask_b32 v9, 0, v5, vcc
    v_cndmask_b32 v10, 0, v6, vcc
    v_cndmask_b32 v11, 0, v7, vcc
    v_cmp_eq_u32 vcc, 1, v32
    s_nop 1
    v_cndmask_b32 v12, 0, v4, vcc
    v_cndmask_b32 v13, 0, v5, vcc
    v_cndmask_b32 v14, 0, v6, vcc
    v_cndmask_b32 v15, 0, v7, vcc
    v_cmp_eq_u32 vcc, 2, v32
    s_nop 1
    v_cndmask_b32 v16, 0, v4, vcc
    v_cndmask_b32 v17, 0, v5, vcc
    v_cndmask_b32 v18, 0, v6, vcc
    v_cndmask_b32 v19, 0, v7, vcc
    v_cmp_eq_u32 vcc, 3, v32
    s_nop 1
    v_cndmask_b32 v20, 0, v4, vcc
    v_cndmask_b32 v21, 0, v5, vcc
    v_cndmask_b32 v22, 0, v6, vcc
    v_cndmask_b32 v23, 0, v7, vcc
    s_waitcnt vmcnt(8)
    v_mfma_f32_16x16x32_bf16 v[4:7], v[8:11], v[40:43], 0
    v_mfma_f32_16x16x32_bf16 v[4:7], v[12:15], v[44:47], v[4:7]
    v_mfma_f32_16x16x32_bf16 v[4:7], v[16:19], v[48:51], v[4:7]
    v_mfma_f32_16x16x32_bf16 v[4:7], v[20:23], v[52:55], v[4:7]
    v_mfma_f32_16x16x32_bf16 v[32:35], v[8:11], v[56:59], 0
    v_mfma_f32_16x16x32_bf16 v[32:35], v[12:15], v[60:63], v[32:35]
    v_mfma_f32_16x16x32_bf16 v[32:35], v[16:19], v[64:67], v[32:35]
    v_mfma_f32_16x16x32_bf16 v[32:35], v[20:23], v[68:71], v[32:35]
    s_nop 3
    v_mov_b32_dpp v24, v4 quad_perm:[0,0,0,0] row_mask:0xf bank_mask:0xf
    s_nop 1
    v_add_f32_dpp v24, v5, v24 quad_perm:[1,1,1,1] row_mask:0xf bank_mask:0xf
    s_nop 1
    v_add_f32_dpp v24, v6, v24 quad_perm:[2,2,2,2] row_mask:0xf bank_mask:0xf
    s_nop 1
    v_add_f32_dpp v24, v7, v24 quad_perm:[3,3,3,3] row_mask:0xf bank_mask:0xf
    v_mfma_f32_16x16x32_bf16 v[4:7], v[8:11], v[72:75], 0
    v_mfma_f32_16x16x32_bf16 v[4:7], v[12:15], v[76:79], v[4:7]
    v_mfma_f32_16x16x32_bf16 v[4:7], v[16:19], v[80:83], v[4:7]
    v_mfma_f32_16x16x32_bf16 v[4:7], v[20:23], v[84:87], v[4:7]
    v_mov_b32_dpp v25, v32 quad_perm:[0,0,0,0] row_mask:0xf bank_mask:0xf
    s_nop 1
    v_add_f32_dpp v25, v33, v25 quad_perm:[1,1,1,1] row_mask:0xf bank_mask:0xf
    s_nop 1
    v_add_f32_dpp v25, v34, v25 quad_perm:[2,2,2,2] row_mask:0xf bank_mask:0xf
    s_nop 1
    v_add_f32_dpp v25, v35, v25 quad_perm:[3,3,3,3] row_mask:0xf bank_mask:0xf
    v_mfma_f32_16x16x32_bf16 v[32:35], v[8:11], v[88:91], 0
    v_mfma_f32_16x16x32_bf16 v[32:35], v[12:15], v[92:95], v[32:35]
    v_mfma_f32_16x16x32_bf16 v[32:35], v[16:19], v[96:99], v[32:35]
    v_mfma_f32_16x16x32_bf16 v[32:35], v[20:23], v[100:103], v[32:35]
    v_mov_b32_dpp v26, v4 quad_perm:[0,0,0,0] row_mask:0xf bank_mask:0xf
    s_nop 1
    v_add_f32_dpp v26, v5, v26 quad_perm:[1,1,1,1] row_mask:0xf bank_mask:0xf
    s_nop 1
    v_add_f32_dpp v26, v6, v26 quad_perm:[2,2,2,2] row_mask:0xf bank_mask:0xf
    s_nop 1
    v_add_f32_dpp v26, v7, v26 quad_perm:[3,3,3,3] row_mask:0xf bank_mask:0xf
    v_mfma_f32_16x16x32_bf16 v[4:7], v[8:11], v[104:107], 0
    v_mfma_f32_16x16x32_bf16 v[4:7], v[12:15], v[108:111], v[4:7]
    v_mfma_f32_16x16x32_bf16 v[4:7], v[16:19], v[112:115], v[4:7]
    v_mfma_f32_16x16x32_bf16 v[4:7], v[20:23], v[116:119], v[4:7]
    v_mov_b32_dpp v27, v32 quad_perm:[0,0,0,0] row_mask:0xf bank_mask:0xf
    s_nop 1
    v_add_f32_dpp v27, v33, v27 quad_perm:[1,1,1,1] row_mask:0xf bank_mask:0xf
    s_nop 1
    v_add_f32_dpp v27, v34, v27 quad_perm:[2,2,2,2] row_mask:0xf bank_mask:0xf
    s_nop 1
    v_add_f32_dpp v27, v35, v27 quad_perm:[3,3,3,3] row_mask:0xf bank_mask:0xf
    v_mfma_f32_16x16x32_bf16 v[32:35], v[8:11], v[120:123], 0
    v_mfma_f32_16x16x32_bf16 v[32:35], v[12:15], v[124:127], v[32:35]
    v_mfma_f32_16x16x32_bf16 v[32:35], v[16:19], v[128:131], v[32:35]
    v_mfma_f32_16x16x32_bf16 v[32:35], v[20:23], v[132:135], v[32:35]
    v_mov_b32_dpp v28, v4 quad_perm:[0,0,0,0] row_mask:0xf bank_mask:0xf
    s_nop 1
    v_add_f32_dpp v28, v5, v28 quad_perm:[1,1,1,1] row_mask:0xf bank_mask:0xf
    s_nop 1
    v_add_f32_dpp v28, v6, v28 quad_perm:[2,2,2,2] row_mask:0xf bank_mask:0xf
    s_nop 1
    v_add_f32_dpp v28, v7, v28 quad_perm:[3,3,3,3] row_mask:0xf bank_mask:0xf
    v_mfma_f32_16x16x32_bf16 v[4:7], v[8:11], v[136:139], 0
    v_mfma_f32_16x16x32_bf16 v[4:7], v[12:15], v[140:143], v[4:7]
    v_mfma_f32_16x16x32_bf16 v[4:7], v[16:19], v[144:147], v[4:7]
    v_mfma_f32_16x16x32_bf16 v[4:7], v[20:23], v[148:151], v[4:7]
    v_mov_b32_dpp v29, v32 quad_perm:[0,0,0,0] row_mask:0xf bank_mask:0xf
    s_nop 1
    v_add_f32_dpp v29, v33, v29 quad_perm:[1,1,1,1] row_mask:0xf bank_mask:0xf
    s_nop 1
    v_add_f32_dpp v29, v34, v29 quad_perm:[2,2,2,2] row_mask:0xf bank_mask:0xf
    s_nop 1
    v_add_f32_dpp v29, v35, v29 quad_perm:[3,3,3,3] row_mask:0xf bank_mask:0xf
    v_mfma_f32_16x16x32_bf16 v[32:35], v[8:11], v[152:155], 0
    v_mfma_f32_16x16x32_bf16 v[32:35], v[12:15], v[156:159], v[32:35]
    v_mfma_f32_16x16x32_bf16 v[32:35], v[16:19], v[160:163], v[32:35]
    v_mfma_f32_16x16x32_bf16 v[32:35], v[20:23], v[164:167], v[32:35]
    v_mov_b32_dpp v30, v4 quad_perm:[0,0,0,0] row_mask:0xf bank_mask:0xf
    s_nop 1
    v_add_f32_dpp v30, v5, v30 quad_perm:[1,1,1,1] row_mask:0xf bank_mask:0xf
    s_nop 1
    v_add_f32_dpp v30, v6, v30 quad_perm:[2,2,2,2] row_mask:0xf bank_mask:0xf
    s_nop 1
    v_add_f32_dpp v30, v7, v30 quad_perm:[3,3,3,3] row_mask:0xf bank_mask:0xf
    v_mov_b32_dpp v31, v32 quad_perm:[0,0,0,0] row_mask:0xf bank_mask:0xf
    s_nop 1
    v_add_f32_dpp v31, v33, v31 quad_perm:[1,1,1,1] row_mask:0xf bank_mask:0xf
    s_nop 1
    v_add_f32_dpp v31, v34, v31 quad_perm:[2,2,2,2] row_mask:0xf bank_mask:0xf
    s_nop 1
    v_add_f32_dpp v31, v35, v31 quad_perm:[3,3,3,3] row_mask:0xf bank_mask:0xf
    v_cvt_pk_bf16_f32 v24, v24, v24
    v_and_b32 v24, 0xffff0000, v24
    v_cvt_pk_bf16_f32 v25, v25, v25
    v_and_b32 v25, 0xffff0000, v25
    v_cvt_pk_bf16_f32 v26, v26, v26
    v_and_b32 v26, 0xffff0000, v26
    v_cvt_pk_bf16_f32 v27, v27, v27
    v_and_b32 v27, 0xffff0000, v27
    v_cvt_pk_bf16_f32 v28, v28, v28
    v_and_b32 v28, 0xffff0000, v28
    v_cvt_pk_bf16_f32 v29, v29, v29
    v_and_b32 v29, 0xffff0000, v29
    v_cvt_pk_bf16_f32 v30, v30, v30
    v_and_b32 v30, 0xffff0000, v30
    v_cvt_pk_bf16_f32 v31, v31, v31
    v_and_b32 v31, 0xffff0000, v31
    v_mul_f32 v24, 0x3db504f3, v24
    v_mul_f32 v25, 0x3db504f3, v25
    v_mul_f32 v26, 0x3db504f3, v26
    v_mul_f32 v27, 0x3db504f3, v27
    v_mul_f32 v28, 0x3db504f3, v28
    v_mul_f32 v29, 0x3db504f3, v29
    v_mul_f32 v30, 0x3db504f3, v30
    v_mul_f32 v31, 0x3db504f3, v31
    v_cvt_pk_bf16_f32 v24, v24, v24
    v_and_b32 v24, 0xffff0000, v24
    v_cvt_pk_bf16_f32 v25, v25, v25
    v_and_b32 v25, 0xffff0000, v25
    v_cvt_pk_bf16_f32 v26, v26, v26
    v_and_b32 v26, 0xffff0000, v26
    v_cvt_pk_bf16_f32 v27, v27, v27
    v_and_b32 v27, 0xffff0000, v27
    v_cvt_pk_bf16_f32 v28, v28, v28
    v_and_b32 v28, 0xffff0000, v28
    v_cvt_pk_bf16_f32 v29, v29, v29
    v_and_b32 v29, 0xffff0000, v29
    v_cvt_pk_bf16_f32 v30, v30, v30
    v_and_b32 v30, 0xffff0000, v30
    v_cvt_pk_bf16_f32 v31, v31, v31
    v_and_b32 v31, 0xffff0000, v31
    v_max3_f32 v4, v24, v25, v26
    v_max3_f32 v4, v4, v27, v28
    v_max3_f32 v4, v4, v29, v30
    v_max_f32 v4, v4, v31
    s_nop 1
    v_max_f32_dpp v4, v4, v4 row_ror:4 row_mask:0xf bank_mask:0xf
    s_nop 1
    v_max_f32_dpp v4, v4, v4 row_ror:8 row_mask:0xf bank_mask:0xf
    v_sub_f32 v8, v24, v4
    v_sub_f32 v9, v25, v4
    v_sub_f32 v10, v26, v4
    v_sub_f32 v11, v27, v4
    v_sub_f32 v12, v28, v4
    v_sub_f32 v13, v29, v4
    v_sub_f32 v14, v30, v4
    v_sub_f32 v15, v31, v4
    v_mul_f32 v8, 0x3fb8aa3b, v8
    v_mul_f32 v9, 0x3fb8aa3b, v9
    v_mul_f32 v10, 0x3fb8aa3b, v10
    v_mul_f32 v11, 0x3fb8aa3b, v11
    v_mul_f32 v12, 0x3fb8aa3b, v12
    v_mul_f32 v13, 0x3fb8aa3b, v13
    v_mul_f32 v14, 0x3fb8aa3b, v14
    v_mul_f32 v15, 0x3fb8aa3b, v15
    v_exp_f32 v8, v8
    v_exp_f32 v9, v9
    v_exp_f32 v10, v10
    v_exp_f32 v11, v11
    v_exp_f32 v12, v12
    v_exp_f32 v13, v13
    v_exp_f32 v14, v14
    v_exp_f32 v15, v15
    v_add_f32 v8, v8, v9
    v_add_f32 v10, v10, v11
    v_add_f32 v12, v12, v13
    v_add_f32 v14, v14, v15
    v_add_f32 v8, v8, v10
    v_add_f32 v12, v12, v14
    v_add_f32 v5, v8, v12
    s_nop 1
    v_add_f32_dpp v5, v5, v5 row_ror:4 row_mask:0xf bank_mask:0xf
    s_nop 1
    v_add_f32_dpp v5, v5, v5 row_ror:8 row_mask:0xf bank_mask:0xf
    v_lshrrev_b32 v3, 4, v0
    v_lshlrev_b32 v3, 3, v3
    s_lshl_b32 s9, s3, 5
    v_add_u32 v3, s9, v3
    v_mov_b32 v6, 0
    v_mov_b32 v7, 1
    s_mov_b32 s48, 0x00010001
    s_mov_b32 s49, 0x00010001
    s_mov_b64 exec, s[48:49]
    ds_write_b64 v3, v[4:5] offset:512
    s_waitcnt lgkmcnt(0)
    s_mov_b64 exec, 1
    ds_add_u32 v6, v7 offset:0
    s_mov_b64 exec, -1
    s_setprio 0
    s_cmp_lt_u32 s3, 4
    s_cbranch_scc1 L_vp
    s_setprio 1
L_vp:
    s_mov_b64 vcc, s[50:51]
    s_cmp_gt_u32 s14, 2
    s_cbranch_scc1 Lvs_48
    s_add_u32 m0, s13, 8192
    s_waitcnt vmcnt(5)
    global_load_lds_dwordx4 v2, s[46:47] offset:0 nt
    s_add_u32 m0, s13, 8960
    s_waitcnt vmcnt(5)
    global_load_lds_dwordx4 v2, s[46:47] offset:256 nt
    s_add_u32 m0, s13, 9728
    s_waitcnt vmcnt(5)
    global_load_lds_dwordx4 v2, s[46:47] offset:512 nt
    s_add_u32 m0, s13, 10496
    s_waitcnt vmcnt(5)
    global_load_lds_dwordx4 v2, s[46:47] offset:768 nt
    s_add_u32 s46, s46, 0x8000
    s_addc_u32 s47, s47, 0
Lvs_48:
    s_cmp_gt_u32 s14, 3
    s_cbranch_scc1 Lvs_49
    s_add_u32 m0, s13, 12288
    s_waitcnt vmcnt(5)
    global_load_lds_dwordx4 v2, s[46:47] offset:0 nt
    s_add_u32 m0, s13, 13056
    s_waitcnt vmcnt(5)
    global_load_lds_dwordx4 v2, s[46:47] offset:256 nt
    s_add_u32 m0, s13, 13824
    s_waitcnt vmcnt(5)
    global_load_lds_dwordx4 v2, s[46:47] offset:512 nt
    s_add_u32 m0, s13, 14592
    s_waitcnt vmcnt(5)
    global_load_lds_dwordx4 v2, s[46:47] offset:768 nt
    s_add_u32 s46, s46, 0x8000
    s_addc_u32 s47, s47, 0
Lvs_49:
    s_waitcnt vmcnt(5)
    global_load_dwordx4 v[40:43], v2, s[46:47] offset:0 nt
    s_waitcnt vmcnt(5)
    global_load_dwordx4 v[44:47], v2, s[46:47] offset:256 nt
    s_waitcnt vmcnt(5)
    global_load_dwordx4 v[48:51], v2, s[46:47] offset:512 nt
    s_waitcnt vmcnt(5)
    global_load_dwordx4 v[52:55], v2, s[46:47] offset:768 nt
    s_add_u32 s46, s46, 0x8000
    s_addc_u32 s47, s47, 0
    s_waitcnt vmcnt(5)
    global_load_dwordx4 v[56:59], v2, s[46:47] offset:0 nt
    s_waitcnt vmcnt(5)
    global_load_dwordx4 v[60:63], v2, s[46:47] offset:256 nt
    s_waitcnt vmcnt(5)
    global_load_dwordx4 v[64:67], v2, s[46:47] offset:512 nt
    s_waitcnt vmcnt(5)
    global_load_dwordx4 v[68:71], v2, s[46:47] offset:768 nt
    s_add_u32 s46, s46, 0x8000
    s_addc_u32 s47, s47, 0
    s_waitcnt vmcnt(5)
    global_load_dwordx4 v[72:75], v2, s[46:47] offset:0 nt
    s_waitcnt vmcnt(5)
    global_load_dwordx4 v[76:79], v2, s[46:47] offset:256 nt
    s_waitcnt vmcnt(5)
    global_load_dwordx4 v[80:83], v2, s[46:47] offset:512 nt
    s_waitcnt vmcnt(5)
    global_load_dwordx4 v[84:87], v2, s[46:47] offset:768 nt
    s_add_u32 s46, s46, 0x8000
    s_addc_u32 s47, s47, 0
    s_waitcnt vmcnt(5)
    global_load_dwordx4 v[88:91], v2, s[46:47] offset:0 nt
    s_waitcnt vmcnt(5)
    global_load_dwordx4 v[92:95], v2, s[46:47] offset:256 nt
    s_waitcnt vmcnt(5)
    global_load_dwordx4 v[96:99], v2, s[46:47] offset:512 nt
    s_waitcnt vmcnt(5)
    global_load_dwordx4 v[100:103], v2, s[46:47] offset:768 nt
    s_mov_b64 exec, 1
    ds_add_u32 v6, v7 offset:8
    s_mov_b64 exec, -1
    v_lshl_add_u32 v3, v0, 4, s13
    ds_read_b128 v[104:107], v3 offset:0
    ds_read_b128 v[108:111], v3 offset:1024
    ds_read_b128 v[112:115], v3 offset:2048
    ds_read_b128 v[116:119], v3 offset:3072
    ds_read_b128 v[120:123], v3 offset:4096
    ds_read_b128 v[124:127], v3 offset:5120
    ds_read_b128 v[128:131], v3 offset:6144
    ds_read_b128 v[132:135], v3 offset:7168
    ds_read_b128 v[136:139], v3 offset:8192
    ds_read_b128 v[140:143], v3 offset:9216
    ds_read_b128 v[144:147], v3 offset:10240
    ds_read_b128 v[148:151], v3 offset:11264
    ds_read_b128 v[152:155], v3 offset:12288
    ds_read_b128 v[156:159], v3 offset:13312
    ds_read_b128 v[160:163], v3 offset:14336
    ds_read_b128 v[164:167], v3 offset:15360
    v_and_b32 v32, 1, v0
    v_lshlrev_b32 v32, 4, v32
    v_mov_b32 v33, 0xffff
    v_lshlrev_b32 v33, v32, v33
    v_and_b32 v32, 15, v0
    v_lshrrev_b32 v32, 1, v32
    v_cmp_eq_u32 vcc, 0, v32
    s_nop 1
    v_cndmask_b32 v16, 0, v33, vcc
    v_cmp_eq_u32 vcc, 1, v32
    s_nop 1
    v_cndmask_b32 v17, 0, v33, vcc
    v_cmp_eq_u32 vcc, 2, v32
    s_nop 1
    v_cndmask_b32 v18, 0, v33, vcc
    v_cmp_eq_u32 vcc, 3, v32
    s_nop 1
    v_cndmask_b32 v19, 0, v33, vcc
    v_lshlrev_b32 v34, 3, v0
    s_lshl_b32 s9, s6, 10
    s_add_u32 s9, s9, 1310720
    v_lshl_add_u32 v35, v0, 4, s9
    s_add_u32 s58, s58, 1
    v_mov_b32 v37, s58
    v_mov_b32 v39, s58
    s_mov_b32 s60, 300000
Lspin_50:
    ds_read_b32 v32, v6 offset:4
    s_waitcnt lgkmcnt(0)
    v_readfirstlane_b32 s9, v32
    s_nop 0
    s_cmp_ge_u32 s9, 1
    s_cbranch_scc1 Lsdone_51
    s_sub_u32 s60, s60, 1
    s_cbranch_scc1 Lsdone_51
    s_sleep 2
    s_branch Lspin_50
Lsdone_51:
    ds_read_b64 v[4:5], v6 offset:32
    s_waitcnt lgkmcnt(0)
    v_sub_f32 v24, v24, v4
    v_sub_f32 v25, v25, v4
    v_sub_f32 v26, v26, v4
    v_sub_f32 v27, v27, v4
    v_sub_f32 v28, v28, v4
    v_sub_f32 v29, v29, v4
    v_sub_f32 v30, v30, v4
    v_sub_f32 v31, v31, v4
    v_mul_f32 v24, 0x3fb8aa3b, v24
    v_mul_f32 v25, 0x3fb8aa3b, v25
    v_mul_f32 v26, 0x3fb8aa3b, v26
    v_mul_f32 v27, 0x3fb8aa3b, v27
    v_mul_f32 v28, 0x3fb8aa3b, v28
    v_mul_f32 v29, 0x3fb8aa3b, v29
    v_mul_f32 v30, 0x3fb8aa3b, v30
    v_mul_f32 v31, 0x3fb8aa3b, v31
    v_exp_f32 v24, v24
    v_exp_f32 v25, v25
    v_exp_f32 v26, v26
    v_exp_f32 v27, v27
    v_exp_f32 v28, v28
    v_exp_f32 v29, v29
    v_exp_f32 v30, v30
    v_exp_f32 v31, v31
    v_mul_f32 v24, v24, v5
    v_mul_f32 v25, v25, v5
    v_mul_f32 v26, v26, v5
    v_mul_f32 v27, v27, v5
    v_mul_f32 v28, v28, v5
    v_mul_f32 v29, v29, v5
    v_mul_f32 v30, v30, v5
    v_mul_f32 v31, v31, v5
    v_cvt_pk_bf16_f32 v24, v24, v24
    v_cvt_pk_bf16_f32 v25, v25, v25
    v_cvt_pk_bf16_f32 v26, v26, v26
    v_cvt_pk_bf16_f32 v27, v27, v27
    v_cvt_pk_bf16_f32 v28, v28, v28
    v_cvt_pk_bf16_f32 v29, v29, v29
    v_cvt_pk_bf16_f32 v30, v30, v30
    v_cvt_pk_bf16_f32 v31, v31, v31
    v_and_b32_dpp v8, v24, v16 row_newbcast:0 row_mask:0xf bank_mask:0xf
    v_and_b32_dpp v9, v24, v17 row_newbcast:0 row_mask:0xf bank_mask:0xf
    v_and_b32_dpp v10, v24, v18 row_newbcast:0 row_mask:0xf bank_mask:0xf
    v_and_b32_dpp v11, v24, v19 row_newbcast:0 row_mask:0xf bank_mask:0xf
    v_and_b32_dpp v12, v24, v16 row_newbcast:4 row_mask:0xf bank_mask:0xf
    v_and_b32_dpp v13, v24, v17 row_newbcast:4 row_mask:0xf bank_mask:0xf
    v_and_b32_dpp v14, v24, v18 row_newbcast:4 row_mask:0xf bank_mask:0xf
    v_and_b32_dpp v15, v24, v19 row_newbcast:4 row_mask:0xf bank_mask:0xf
    v_mfma_f32_16x16x32_bf16 v[20:23], v[8:11], v[104:107], 0
    v_and_b32_dpp v8, v24, v16 row_newbcast:8 row_mask:0xf bank_mask:0xf
    v_and_b32_dpp v9, v24, v17 row_newbcast:8 row_mask:0xf bank_mask:0xf
    v_and_b32_dpp v10, v24, v18 row_newbcast:8 row_mask:0xf bank_mask:0xf
    v_and_b32_dpp v11, v24, v19 row_newbcast:8 row_mask:0xf bank_mask:0xf
    v_mfma_f32_16x16x32_bf16 v[20:23], v[12:15], v[108:111], v[20:23]
    v_and_b32_dpp v12, v24, v16 row_newbcast:12 row_mask:0xf bank_mask:0xf
    v_and_b32_dpp v13, v24, v17 row_newbcast:12 row_mask:0xf bank_mask:0xf
    v_and_b32_dpp v14, v24, v18 row_newbcast:12 row_mask:0xf bank_mask:0xf
    v_and_b32_dpp v15, v24, v19 row_newbcast:12 row_mask:0xf bank_mask:0xf
    v_mfma_f32_16x16x32_bf16 v[20:23], v[8:11], v[112:115], v[20:23]
    v_and_b32_dpp v8, v25, v16 row_newbcast:0 row_mask:0xf bank_mask:0xf
    v_and_b32_dpp v9, v25, v17 row_newbcast:0 row_mask:0xf bank_mask:0xf
    v_and_b32_dpp v10, v25, v18 row_newbcast:0 row_mask:0xf bank_mask:0xf
    v_and_b32_dpp v11, v25, v19 row_newbcast:0 row_mask:0xf bank_mask:0xf
    v_mfma_f32_16x16x32_bf16 v[20:23], v[12:15], v[116:119], v[20:23]
    v_and_b32_dpp v12, v25, v16 row_newbcast:4 row_mask:0xf bank_mask:0xf
    v_and_b32_dpp v13, v25, v17 row_newbcast:4 row_mask:0xf bank_mask:0xf
    v_and_b32_dpp v14, v25, v18 row_newbcast:4 row_mask:0xf bank_mask:0xf
    v_and_b32_dpp v15, v25, v19 row_newbcast:4 row_mask:0xf bank_mask:0xf
    v_mfma_f32_16x16x32_bf16 v[20:23], v[8:11], v[120:123], v[20:23]
    v_and_b32_dpp v8, v25, v16 row_newbcast:8 row_mask:0xf bank_mask:0xf
    v_and_b32_dpp v9, v25, v17 row_newbcast:8 row_mask:0xf bank_mask:0xf
    v_and_b32_dpp v10, v25, v18 row_newbcast:8 row_mask:0xf bank_mask:0xf
    v_and_b32_dpp v11, v25, v19 row_newbcast:8 row_mask:0xf bank_mask:0xf
    v_mfma_f32_16x16x32_bf16 v[20:23], v[12:15], v[124:127], v[20:23]
    v_and_b32_dpp v12, v25, v16 row_newbcast:12 row_mask:0xf bank_mask:0xf
    v_and_b32_dpp v13, v25, v17 row_newbcast:12 row_mask:0xf bank_mask:0xf
    v_and_b32_dpp v14, v25, v18 row_newbcast:12 row_mask:0xf bank_mask:0xf
    v_and_b32_dpp v15, v25, v19 row_newbcast:12 row_mask:0xf bank_mask:0xf
    v_mfma_f32_16x16x32_bf16 v[20:23], v[8:11], v[128:131], v[20:23]
    v_and_b32_dpp v8, v26, v16 row_newbcast:0 row_mask:0xf bank_mask:0xf
    v_and_b32_dpp v9, v26, v17 row_newbcast:0 row_mask:0xf bank_mask:0xf
    v_and_b32_dpp v10, v26, v18 row_newbcast:0 row_mask:0xf bank_mask:0xf
    v_and_b32_dpp v11, v26, v19 row_newbcast:0 row_mask:0xf bank_mask:0xf
    v_mfma_f32_16x16x32_bf16 v[20:23], v[12:15], v[132:135], v[20:23]
    v_and_b32_dpp v12, v26, v16 row_newbcast:4 row_mask:0xf bank_mask:0xf
    v_and_b32_dpp v13, v26, v17 row_newbcast:4 row_mask:0xf bank_mask:0xf
    v_and_b32_dpp v14, v26, v18 row_newbcast:4 row_mask:0xf bank_mask:0xf
    v_and_b32_dpp v15, v26, v19 row_newbcast:4 row_mask:0xf bank_mask:0xf
    v_mfma_f32_16x16x32_bf16 v[20:23], v[8:11], v[136:139], v[20:23]
    v_and_b32_dpp v8, v26, v16 row_newbcast:8 row_mask:0xf bank_mask:0xf
    v_and_b32_dpp v9, v26, v17 row_newbcast:8 row_mask:0xf bank_mask:0xf
    v_and_b32_dpp v10, v26, v18 row_newbcast:8 row_mask:0xf bank_mask:0xf
    v_and_b32_dpp v11, v26, v19 row_newbcast:8 row_mask:0xf bank_mask:0xf
    v_mfma_f32_16x16x32_bf16 v[20:23], v[12:15], v[140:143], v[20:23]
    v_and_b32_dpp v12, v26, v16 row_newbcast:12 row_mask:0xf bank_mask:0xf
    v_and_b32_dpp v13, v26, v17 row_newbcast:12 row_mask:0xf bank_mask:0xf
    v_and_b32_dpp v14, v26, v18 row_newbcast:12 row_mask:0xf bank_mask:0xf
    v_and_b32_dpp v15, v26, v19 row_newbcast:12 row_mask:0xf bank_mask:0xf
    v_mfma_f32_16x16x32_bf16 v[20:23], v[8:11], v[144:147], v[20:23]
    v_and_b32_dpp v8, v27, v16 row_newbcast:0 row_mask:0xf bank_mask:0xf
    v_and_b32_dpp v9, v27, v17 row_newbcast:0 row_mask:0xf bank_mask:0xf
    v_and_b32_dpp v10, v27, v18 row_newbcast:0 row_mask:0xf bank_mask:0xf
    v_and_b32_dpp v11, v27, v19 row_newbcast:0 row_mask:0xf bank_mask:0xf
    v_mfma_f32_16x16x32_bf16 v[20:23], v[12:15], v[148:151], v[20:23]
    v_and_b32_dpp v12, v27, v16 row_newbcast:4 row_mask:0xf bank_mask:0xf
    v_and_b32_dpp v13, v27, v17 row_newbcast:4 row_mask:0xf bank_mask:0xf
    v_and_b32_dpp v14, v27, v18 row_newbcast:4 row_mask:0xf bank_mask:0xf
    v_and_b32_dpp v15, v27, v19 row_newbcast:4 row_mask:0xf bank_mask:0xf
    v_mfma_f32_16x16x32_bf16 v[20:23], v[8:11], v[152:155], v[20:23]
    v_and_b32_dpp v8, v27, v16 row_newbcast:8 row_mask:0xf bank_mask:0xf
    v_and_b32_dpp v9, v27, v17 row_newbcast:8 row_mask:0xf bank_mask:0xf
    v_and_b32_dpp v10, v27, v18 row_newbcast:8 row_mask:0xf bank_mask:0xf
    v_and_b32_dpp v11, v27, v19 row_newbcast:8 row_mask:0xf bank_mask:0xf
    v_mfma_f32_16x16x32_bf16 v[20:23], v[12:15], v[156:159], v[20:23]
    v_and_b32_dpp v12, v27, v16 row_newbcast:12 row_mask:0xf bank_mask:0xf
    v_and_b32_dpp v13, v27, v17 row_newbcast:12 row_mask:0xf bank_mask:0xf
    v_and_b32_dpp v14, v27, v18 row_newbcast:12 row_mask:0xf bank_mask:0xf
    v_and_b32_dpp v15, v27, v19 row_newbcast:12 row_mask:0xf bank_mask:0xf
    v_mfma_f32_16x16x32_bf16 v[20:23], v[8:11], v[160:163], v[20:23]
    v_and_b32_dpp v8, v28, v16 row_newbcast:0 row_mask:0xf bank_mask:0xf
    v_and_b32_dpp v9, v28, v17 row_newbcast:0 row_mask:0xf bank_mask:0xf
    v_and_b32_dpp v10, v28, v18 row_newbcast:0 row_mask:0xf bank_mask:0xf
    v_and_b32_dpp v11, v28, v19 row_newbcast:0 row_mask:0xf bank_mask:0xf
    v_mfma_f32_16x16x32_bf16 v[20:23], v[12:15], v[164:167], v[20:23]
    v_and_b32_dpp v12, v28, v16 row_newbcast:4 row_mask:0xf bank_mask:0xf
    v_and_b32_dpp v13, v28, v17 row_newbcast:4 row_mask:0xf bank_mask:0xf
    v_and_b32_dpp v14, v28, v18 row_newbcast:4 row_mask:0xf bank_mask:0xf
    v_and_b32_dpp v15, v28, v19 row_newbcast:4 row_mask:0xf bank_mask:0xf
    v_mfma_f32_16x16x32_bf16 v[20:23], v[8:11], v[40:43], v[20:23]
    v_and_b32_dpp v8, v28, v16 row_newbcast:8 row_mask:0xf bank_mask:0xf
    v_and_b32_dpp v9, v28, v17 row_newbcast:8 row_mask:0xf bank_mask:0xf
    v_and_b32_dpp v10, v28, v18 row_newbcast:8 row_mask:0xf bank_mask:0xf
    v_and_b32_dpp v11, v28, v19 row_newbcast:8 row_mask:0xf bank_mask:0xf
    v_mfma_f32_16x16x32_bf16 v[20:23], v[12:15], v[44:47], v[20:23]
    v_and_b32_dpp v12, v28, v16 row_newbcast:12 row_mask:0xf bank_mask:0xf
    v_and_b32_dpp v13, v28, v17 row_newbcast:12 row_mask:0xf bank_mask:0xf
    v_and_b32_dpp v14, v28, v18 row_newbcast:12 row_mask:0xf bank_mask:0xf
    v_and_b32_dpp v15, v28, v19 row_newbcast:12 row_mask:0xf bank_mask:0xf
    v_mfma_f32_16x16x32_bf16 v[20:23], v[8:11], v[48:51], v[20:23]
    v_and_b32_dpp v8, v29, v16 row_newbcast:0 row_mask:0xf bank_mask:0xf
    v_and_b32_dpp v9, v29, v17 row_newbcast:0 row_mask:0xf bank_mask:0xf
    v_and_b32_dpp v10, v29, v18 row_newbcast:0 row_mask:0xf bank_mask:0xf
    v_and_b32_dpp v11, v29, v19 row_newbcast:0 row_mask:0xf bank_mask:0xf
    v_mfma_f32_16x16x32_bf16 v[20:23], v[12:15], v[52:55], v[20:23]
    v_and_b32_dpp v12, v29, v16 row_newbcast:4 row_mask:0xf bank_mask:0xf
    v_and_b32_dpp v13, v29, v17 row_newbcast:4 row_mask:0xf bank_mask:0xf
    v_and_b32_dpp v14, v29, v18 row_newbcast:4 row_mask:0xf bank_mask:0xf
    v_and_b32_dpp v15, v29, v19 row_newbcast:4 row_mask:0xf bank_mask:0xf
    v_mfma_f32_16x16x32_bf16 v[20:23], v[8:11], v[56:59], v[20:23]
    v_and_b32_dpp v8, v29, v16 row_newbcast:8 row_mask:0xf bank_mask:0xf
    v_and_b32_dpp v9, v29, v17 row_newbcast:8 row_mask:0xf bank_mask:0xf
    v_and_b32_dpp v10, v29, v18 row_newbcast:8 row_mask:0xf bank_mask:0xf
    v_and_b32_dpp v11, v29, v19 row_newbcast:8 row_mask:0xf bank_mask:0xf
    v_mfma_f32_16x16x32_bf16 v[20:23], v[12:15], v[60:63], v[20:23]
    v_and_b32_dpp v12, v29, v16 row_newbcast:12 row_mask:0xf bank_mask:0xf
    v_and_b32_dpp v13, v29, v17 row_newbcast:12 row_mask:0xf bank_mask:0xf
    v_and_b32_dpp v14, v29, v18 row_newbcast:12 row_mask:0xf bank_mask:0xf
    v_and_b32_dpp v15, v29, v19 row_newbcast:12 row_mask:0xf bank_mask:0xf
    v_mfma_f32_16x16x32_bf16 v[20:23], v[8:11], v[64:67], v[20:23]
    v_and_b32_dpp v8, v30, v16 row_newbcast:0 row_mask:0xf bank_mask:0xf
    v_and_b32_dpp v9, v30, v17 row_newbcast:0 row_mask:0xf bank_mask:0xf
    v_and_b32_dpp v10, v30, v18 row_newbcast:0 row_mask:0xf bank_mask:0xf
    v_and_b32_dpp v11, v30, v19 row_newbcast:0 row_mask:0xf bank_mask:0xf
    v_mfma_f32_16x16x32_bf16 v[20:23], v[12:15], v[68:71], v[20:23]
    v_and_b32_dpp v12, v30, v16 row_newbcast:4 row_mask:0xf bank_mask:0xf
    v_and_b32_dpp v13, v30, v17 row_newbcast:4 row_mask:0xf bank_mask:0xf
    v_and_b32_dpp v14, v30, v18 row_newbcast:4 row_mask:0xf bank_mask:0xf
    v_and_b32_dpp v15, v30, v19 row_newbcast:4 row_mask:0xf bank_mask:0xf
    v_mfma_f32_16x16x32_bf16 v[20:23], v[8:11], v[72:75], v[20:23]
    v_and_b32_dpp v8, v30, v16 row_newbcast:8 row_mask:0xf bank_mask:0xf
    v_and_b32_dpp v9, v30, v17 row_newbcast:8 row_mask:0xf bank_mask:0xf
    v_and_b32_dpp v10, v30, v18 row_newbcast:8 row_mask:0xf bank_mask:0xf
    v_and_b32_dpp v11, v30, v19 row_newbcast:8 row_mask:0xf bank_mask:0xf
    v_mfma_f32_16x16x32_bf16 v[20:23], v[12:15], v[76:79], v[20:23]
    v_and_b32_dpp v12, v30, v16 row_newbcast:12 row_mask:0xf bank_mask:0xf
    v_and_b32_dpp v13, v30, v17 row_newbcast:12 row_mask:0xf bank_mask:0xf
    v_and_b32_dpp v14, v30, v18 row_newbcast:12 row_mask:0xf bank_mask:0xf
    v_and_b32_dpp v15, v30, v19 row_newbcast:12 row_mask:0xf bank_mask:0xf
    s_waitcnt vmcnt(5)
    v_mfma_f32_16x16x32_bf16 v[20:23], v[8:11], v[80:83], v[20:23]
    v_and_b32_dpp v8, v31, v16 row_newbcast:0 row_mask:0xf bank_mask:0xf
    v_and_b32_dpp v9, v31, v17 row_newbcast:0 row_mask:0xf bank_mask:0xf
    v_and_b32_dpp v10, v31, v18 row_newbcast:0 row_mask:0xf bank_mask:0xf
    v_and_b32_dpp v11, v31, v19 row_newbcast:0 row_mask:0xf bank_mask:0xf
    s_waitcnt vmcnt(4)
    v_mfma_f32_16x16x32_bf16 v[20:23], v[12:15], v[84:87], v[20:23]
    v_and_b32_dpp v12, v31, v16 row_newbcast:4 row_mask:0xf bank_mask:0xf
    v_and_b32_dpp v13, v31, v17 row_newbcast:4 row_mask:0xf bank_mask:0xf
    v_and_b32_dpp v14, v31, v18 row_newbcast:4 row_mask:0xf bank_mask:0xf
    v_and_b32_dpp v15, v31, v19 row_newbcast:4 row_mask:0xf bank_mask:0xf
    s_waitcnt vmcnt(3)
    v_mfma_f32_16x16x32_bf16 v[20:23], v[8:11], v[88:91], v[20:23]
    v_and_b32_dpp v8, v31, v16 row_newbcast:8 row_mask:0xf bank_mask:0xf
    v_and_b32_dpp v9, v31, v17 row_newbcast:8 row_mask:0xf bank_mask:0xf
    v_and_b32_dpp v10, v31, v18 row_newbcast:8 row_mask:0xf bank_mask:0xf
    v_and_b32_dpp v11, v31, v19 row_newbcast:8 row_mask:0xf bank_mask:0xf
    s_waitcnt vmcnt(2)
    v_mfma_f32_16x16x32_bf16 v[20:23], v[12:15], v[92:95], v[20:23]
    v_and_b32_dpp v12, v31, v16 row_newbcast:12 row_mask:0xf bank_mask:0xf
    v_and_b32_dpp v13, v31, v17 row_newbcast:12 row_mask:0xf bank_mask:0xf
    v_and_b32_dpp v14, v31, v18 row_newbcast:12 row_mask:0xf bank_mask:0xf
    v_and_b32_dpp v15, v31, v19 row_newbcast:12 row_mask:0xf bank_mask:0xf
    s_waitcnt vmcnt(1)
    v_mfma_f32_16x16x32_bf16 v[20:23], v[8:11], v[96:99], v[20:23]
    s_waitcnt vmcnt(0)
    v_mfma_f32_16x16x32_bf16 v[20:23], v[12:15], v[100:103], v[20:23]
    v_and_b32 v3, 15, v0
    v_lshlrev_b32 v3, 5, v3
    v_lshrrev_b32 v32, 4, v0
    v_lshl_add_u32 v3, v32, 4, v3
    s_lshl_b32 s9, s3, 9
    v_add_u32 v3, s9, v3
    s_mov_b32 exec_lo, -1
    s_mov_b32 exec_hi, 0
    ds_write_b128 v3, v[20:23] offset:1024
    s_mov_b64 exec, 1
    ds_add_rtn_u32 v33, v6, v7 offset:16
    s_mov_b64 exec, -1
    s_waitcnt lgkmcnt(0)
    v_readfirstlane_b32 s9, v33
    s_nop 0
    s_cmp_lg_u32 s9, 7
    s_cbranch_scc1 L_nopub
    ds_read_b64 v[40:41], v34 offset:1024
    ds_read_b64 v[42:43], v34 offset:1536
    ds_read_b64 v[44:45], v34 offset:2048
    ds_read_b64 v[46:47], v34 offset:2560
    ds_read_b64 v[48:49], v34 offset:3072
    ds_read_b64 v[50:51], v34 offset:3584
    ds_read_b64 v[52:53], v34 offset:4096
    ds_read_b64 v[54:55], v34 offset:4608
    s_waitcnt lgkmcnt(4)
    v_add_f32 v40, v40, v42
    v_add_f32 v41, v41, v43
    v_add_f32 v44, v44, v46
    v_add_f32 v45, v45, v47
    v_add_f32 v40, v40, v44
    v_add_f32 v41, v41, v45
    s_waitcnt lgkmcnt(0)
    v_add_f32 v48, v48, v50
    v_add_f32 v49, v49, v51
    v_add_f32 v52, v52, v54
    v_add_f32 v53, v53, v55
    v_add_f32 v48, v48, v52
    v_add_f32 v49, v49, v53
    v_add_f32 v36, v40, v48
    v_add_f32 v38, v41, v49
    global_store_dwordx4 v35, v[36:39], s[42:43]
    global_store_dwordx4 v35, v[36:39], s[98:99] sc1
    ds_write_b32 v6, v7 offset:20
L_nopub:
    s_cmp_ge_u32 s5, 18
    s_cbranch_scc1 L_b_exit
    s_mov_b32 s60, 300000
Lspin_52:
    ds_read_b32 v32, v6 offset:20
    s_waitcnt lgkmcnt(0)
    v_readfirstlane_b32 s9, v32
    s_nop 0
    s_cmp_ge_u32 s9, 1
    s_cbranch_scc1 Lsdone_53
    s_sub_u32 s60, s60, 1
    s_cbranch_scc1 Lsdone_53
    s_sleep 2
    s_branch Lspin_52
Lsdone_53:
    s_mov_b32 s60, 300000
Lspin_54:
    ds_read_b32 v32, v6 offset:24
    s_waitcnt lgkmcnt(0)
    v_readfirstlane_b32 s9, v32
    s_nop 0
    s_cmp_ge_u32 s9, 2
    s_cbranch_scc1 Lsdone_55
    s_sub_u32 s60, s60, 1
    s_cbranch_scc1 Lsdone_55
    s_sleep 2
    s_branch Lspin_54
Lsdone_55:
    s_mov_b32 s11, s3
L_hop2:
    v_lshrrev_b32 v63, 4, v0
    v_and_b32 v64, 15, v0
    v_mul_u32_u24 v65, 2304, v63
    v_lshl_add_u32 v65, v64, 4, v65
    s_lshl_b32 s9, s11, 8
    s_add_u32 s12, s9, 393216
    v_add_u32 v65, s12, v65
    v_add_u32 v66, 9216, v65
    v_and_b32 v67, 1, v63
    v_lshlrev_b32 v67, 1, v67
    v_lshrrev_b32 v63, 1, v63
    v_add_u32 v67, v67, v63
    v_lshl_add_u32 v67, v64, 2, v67
    v_lshlrev_b32 v67, 2, v67
    v_add_u32 v67, s9, v67
    ds_read_b32 v68, v67 offset:12032
    ds_read_b32 v69, v67 offset:5120
    s_waitcnt vmcnt(0)
    v_mov_b32 v72, -1
    v_mov_b32 v73, -1
    v_mov_b32 v74, -1
    v_mov_b32 v75, -1
    v_mov_b32 v76, -1
    v_mov_b32 v77, -1
    v_mov_b32 v78, -1
    v_mov_b32 v79, -1
    global_load_dwordx4 v[80:83], v65, s[42:43] sc1
    global_load_dwordx4 v[84:87], v66, s[42:43] sc1
    s_mov_b32 s60, s59
Lpp_56:
    s_waitcnt vmcnt(0)
    v_min_u32 v72, v72, v80
    v_min_u32 v73, v73, v81
    v_min_u32 v74, v74, v82
    v_min_u32 v75, v75, v83
    v_min_u32 v76, v76, v84
    v_min_u32 v77, v77, v85
    v_min_u32 v78, v78, v86
    v_min_u32 v79, v79, v87
    v_max3_u32 v80, v72, v73, v74
    v_max_u32 v80, v80, v75
    v_max3_u32 v84, v76, v77, v78
    v_max_u32 v84, v84, v79
    v_cmp_eq_u32 s[88:89], -1, v80
    v_cmp_eq_u32 s[92:93], -1, v84
    v_mov_b32 v80, -1
    v_mov_b32 v84, -1
    s_bcnt1_i32_b64 s9, s[88:89]
    s_bcnt1_i32_b64 s61, s[92:93]
    s_add_u32 s9, s9, s61
    s_cmp_eq_u32 s9, 0
    s_cbranch_scc1 Lppd_57
    s_cmp_eq_u64 s[88:89], 0
    s_cselect_b64 exec, 1, s[88:89]
    global_load_dwordx4 v[80:83], v65, s[42:43] sc1
    s_cmp_eq_u64 s[92:93], 0
    s_cselect_b64 exec, 1, s[92:93]
    global_load_dwordx4 v[84:87], v66, s[42:43] sc1
    s_mov_b64 exec, -1
    s_sub_u32 s60, s60, 1
    s_cbranch_scc0 Lpp_56
Lppd_57:
    v_add_f32 v72, v72, v76
    v_add_f32 v73, v73, v77
    v_add_f32 v74, v74, v78
    v_add_f32 v75, v75, v79
    v_permlane32_swap_b32 v72, v73
    s_nop 0
    v_permlane32_swap_b32 v74, v75
    v_add_f32 v72, v72, v73
    v_add_f32 v74, v74, v75
    s_nop 1
    v_permlane16_swap_b32 v72, v74
    v_add_f32 v72, v72, v74
    v_cvt_pk_bf16_f32 v72, v72, v72
    v_and_b32 v72, 0xffff0000, v72
    s_waitcnt lgkmcnt(0)
    v_mul_f32 v72, v72, v68
    v_cvt_pk_bf16_f32 v72, v72, v72
    v_and_b32 v72, 0xffff0000, v72
    v_add_f32 v72, v72, v69
    v_cvt_pk_bf16_f32 v72, v72, v72
    v_and_b32 v72, 0xffff0000, v72
    ds_write_b32 v67, v72 offset:21248
    s_waitcnt lgkmcnt(0)
    s_cmp_eq_u32 s11, 8
    s_cbranch_scc1 L_s3pre
    s_barrier
L_b_exit:
    s_endpgm
L_service:
    v_lshlrev_b32 v1, 4, v0
    v_mov_b32 v23, 0
    s_setprio 3
    s_cmp_eq_u32 s3, 1
    s_cbranch_scc1 L_s1
    s_cmp_eq_u32 s3, 2
    s_cbranch_scc1 L_s2
    s_cmp_eq_u32 s3, 3
    s_cbranch_scc1 L_s3
L_s0:
    v_lshrrev_b32 v8, 4, v0
    v_mul_u32_u24 v8, 18, v8
    s_mul_i32 s9, s8, 72
    v_add_u32 v8, s9, v8
    v_lshlrev_b32 v8, 13, v8
    v_and_b32 v9, 15, v0
    v_lshl_add_u32 v8, v9, 4, v8
    s_lshl_b32 s9, s7, 8
    v_add_u32 v8, s9, v8
    v_lshlrev_b32 v9, 2, v0
    v_mov_b32 v28, 0
    s_waitcnt lgkmcnt(0)
    s_mov_b32 exec_lo, -1
    s_mov_b32 exec_hi, 0
    global_load_dword v28, v9, s[16:17] offset:1024
    s_mov_b64 exec, -1
    global_load_dword v24, v9, s[16:17] offset:0
    global_load_dword v25, v9, s[16:17] offset:256
    global_load_dword v26, v9, s[16:17] offset:512
    global_load_dword v27, v9, s[16:17] offset:768
    global_load_dwordx4 v[96:99], v8, s[22:23] nt
    v_add_u32 v8, 0x2000, v8
    global_load_dwordx4 v[100:103], v8, s[22:23] nt
    v_add_u32 v8, 0x2000, v8
    global_load_dwordx4 v[104:107], v8, s[22:23] nt
    v_add_u32 v8, 0x2000, v8
    global_load_dwordx4 v[108:111], v8, s[22:23] nt
    v_add_u32 v8, 0x2000, v8
    global_load_dwordx4 v[112:115], v8, s[22:23] nt
    v_add_u32 v8, 0x2000, v8
    global_load_dwordx4 v[116:119], v8, s[22:23] nt
    v_add_u32 v8, 0x2000, v8
    global_load_dwordx4 v[120:123], v8, s[22:23] nt
    v_add_u32 v8, 0x2000, v8
    global_load_dwordx4 v[124:127], v8, s[22:23] nt
    v_add_u32 v8, 0x2000, v8
    global_load_dwordx4 v[128:131], v8, s[22:23] nt
    v_add_u32 v8, 0x2000, v8
    global_load_dwordx4 v[132:135], v8, s[22:23] nt
    v_add_u32 v8, 0x2000, v8
    global_load_dwordx4 v[136:139], v8, s[22:23] nt
    v_add_u32 v8, 0x2000, v8
    global_load_dwordx4 v[140:143], v8, s[22:23] nt
    v_add_u32 v8, 0x2000, v8
    global_load_dwordx4 v[144:147], v8, s[22:23] nt
    v_add_u32 v8, 0x2000, v8
    global_load_dwordx4 v[148:151], v8, s[22:23] nt
    v_add_u32 v8, 0x2000, v8
    global_load_dwordx4 v[152:155], v8, s[22:23] nt
    v_add_u32 v8, 0x2000, v8
    global_load_dwordx4 v[156:159], v8, s[22:23] nt
    v_add_u32 v8, 0x2000, v8
    global_load_dwordx4 v[160:163], v8, s[22:23] nt
    v_add_u32 v8, 0x2000, v8
    global_load_dwordx4 v[164:167], v8, s[22:23] nt
    s_load_dword s58, s[42:43], 245760
    s_add_u32 s98, s42, 33554432
    s_addc_u32 s99, s43, 0
    s_mov_b64 s[96:97], s[42:43]
    s_barrier
    v_and_b32 v12, 1, v0
    v_lshlrev_b32 v12, 4, v12
    v_mov_b32 v13, 0xffff
    v_lshlrev_b32 v13, v12, v13
    v_and_b32 v12, 15, v0
    v_lshrrev_b32 v12, 1, v12
    v_cmp_eq_u32 vcc, 0, v12
    s_nop 1
    v_cndmask_b32 v16, 0, v13, vcc
    v_cmp_eq_u32 vcc, 1, v12
    s_nop 1
    v_cndmask_b32 v17, 0, v13, vcc
    v_cmp_eq_u32 vcc, 2, v12
    s_nop 1
    v_cndmask_b32 v18, 0, v13, vcc
    v_cmp_eq_u32 vcc, 3, v12
    s_nop 1
    v_cndmask_b32 v19, 0, v13, vcc
    s_mul_i32 s9, s8, 288
    s_add_u32 s9, s9, 0
    v_lshl_add_u32 v15, v0, 3, s9
    s_waitcnt vmcnt(18)
    v_lshlrev_b32 v30, 16, v24
    v_and_b32 v31, 0xffff0000, v24
    v_lshlrev_b32 v32, 16, v25
    v_and_b32 v33, 0xffff0000, v25
    v_lshlrev_b32 v34, 16, v26
    v_and_b32 v35, 0xffff0000, v26
    v_lshlrev_b32 v36, 16, v27
    v_and_b32 v37, 0xffff0000, v27
    v_lshlrev_b32 v38, 16, v28
    v_and_b32 v39, 0xffff0000, v28
    v_lshlrev_b32 v12, 3, v0
    ds_write_b64 v12, v[30:31] offset:5120
    ds_write_b64 v12, v[32:33] offset:5632
    ds_write_b64 v12, v[34:35] offset:6144
    ds_write_b64 v12, v[36:37] offset:6656
    s_mov_b32 exec_lo, -1
    s_mov_b32 exec_hi, 0
    ds_write_b64 v12, v[38:39] offset:7168
    s_mov_b64 exec, -1
    v_add_f32 v10, v30, v31
    v_add_f32 v10, v10, v32
    v_add_f32 v10, v10, v33
    v_add_f32 v10, v10, v34
    v_add_f32 v10, v10, v35
    v_add_f32 v10, v10, v36
    v_add_f32 v10, v10, v37
    v_add_f32 v10, v10, v38
    v_add_f32 v10, v10, v39
    s_nop 1
    v_add_f32_dpp v10, v10, v10 row_ror:8 row_mask:0xf bank_mask:0xf
    s_nop 1
    v_add_f32_dpp v10, v10, v10 row_ror:4 row_mask:0xf bank_mask:0xf
    s_nop 1
    v_add_f32_dpp v10, v10, v10 row_ror:2 row_mask:0xf bank_mask:0xf
    s_nop 1
    v_add_f32_dpp v10, v10, v10 row_ror:1 row_mask:0xf bank_mask:0xf
    v_mov_b32 v11, v10
    s_nop 1
    v_permlane16_swap_b32 v10, v11
    v_add_f32 v10, v10, v11
    v_mov_b32 v11, v10
    s_nop 1
    v_permlane32_swap_b32 v10, v11
    v_add_f32 v10, v10, v11
    v_mul_f32 v10, 0x3ae38e39, v10
    v_mov_b32 v11, 0
    v_sub_f32 v30, v30, v10
    v_fmac_f32 v11, v30, v30
    v_sub_f32 v31, v31, v10
    v_fmac_f32 v11, v31, v31
    v_sub_f32 v32, v32, v10
    v_fmac_f32 v11, v32, v32
    v_sub_f32 v33, v33, v10
    v_fmac_f32 v11, v33, v33
    v_sub_f32 v34, v34, v10
    v_fmac_f32 v11, v34, v34
    v_sub_f32 v35, v35, v10
    v_fmac_f32 v11, v35, v35
    v_sub_f32 v36, v36, v10
    v_fmac_f32 v11, v36, v36
    v_sub_f32 v37, v37, v10
    v_fmac_f32 v11, v37, v37
    s_mov_b32 exec_lo, -1
    s_mov_b32 exec_hi, 0
    v_sub_f32 v38, v38, v10
    v_fmac_f32 v11, v38, v38
    v_sub_f32 v39, v39, v10
    v_fmac_f32 v11, v39, v39
    s_mov_b64 exec, -1
    s_nop 0
    v_add_f32_dpp v11, v11, v11 row_ror:8 row_mask:0xf bank_mask:0xf
    s_nop 1
    v_add_f32_dpp v11, v11, v11 row_ror:4 row_mask:0xf bank_mask:0xf
    s_nop 1
    v_add_f32_dpp v11, v11, v11 row_ror:2 row_mask:0xf bank_mask:0xf
    s_nop 1
    v_add_f32_dpp v11, v11, v11 row_ror:1 row_mask:0xf bank_mask:0xf
    v_mov_b32 v2, v11
    s_nop 1
    v_permlane16_swap_b32 v11, v2
    v_add_f32 v11, v11, v2
    v_mov_b32 v2, v11
    s_nop 1
    v_permlane32_swap_b32 v11, v2
    v_add_f32 v11, v11, v2
    v_mul_f32 v11, 0x3ae38e39, v11
    v_cvt_pk_bf16_f32 v11, v11, v11
    v_and_b32 v11, 0xffff0000, v11
    v_add_f32 v11, 0x3727c5ac, v11
    v_cvt_pk_bf16_f32 v11, v11, v11
    v_and_b32 v11, 0xffff0000, v11
    v_sqrt_f32 v11, v11
    s_nop 0
    v_cvt_pk_bf16_f32 v11, v11, v11
    v_and_b32 v11, 0xffff0000, v11
    v_rcp_f32 v11, v11
    v_cvt_pk_bf16_f32 v10, v10, v10
    v_and_b32 v10, 0xffff0000, v10
    s_mul_i32 s9, s8, 288
    v_add_u32 v2, s9, v12
    s_waitcnt lgkmcnt(0)
    s_add_u32 s58, s58, 1
    ds_read_b64 v[4:5], v2 offset:5120
    v_mov_b32 v65, s58
    v_mov_b32 v67, s58
    v_mov_b32 v69, s58
    v_mov_b32 v71, s58
    v_and_b32 v6, 15, v0
    v_lshlrev_b32 v6, 6, v6
    v_lshrrev_b32 v7, 4, v0
    v_lshl_add_u32 v6, v7, 5, v6
    s_lshl_b32 s9, s6, 10
    s_add_u32 s9, s9, 1048576
    v_add_u32 v6, s9, v6
    s_lshl_b32 s9, s7, 13
    s_add_u32 s9, s9, 1052672
    v_add_u32 v7, s9, v1
    s_waitcnt lgkmcnt(0)
    v_sub_f32 v4, v4, v10
    v_sub_f32 v5, v5, v10
    v_cvt_pk_bf16_f32 v4, v4, v4
    v_and_b32 v4, 0xffff0000, v4
    v_cvt_pk_bf16_f32 v5, v5, v5
    v_and_b32 v5, 0xffff0000, v5
    v_mul_f32 v4, v4, v11
    v_mul_f32 v5, v5, v11
    v_cvt_pk_bf16_f32 v4, v4, v4
    v_and_b32 v4, 0xffff0000, v4
    v_cvt_pk_bf16_f32 v5, v5, v5
    v_and_b32 v5, 0xffff0000, v5
    v_lshlrev_b32 v8, 2, v0
    v_lshrrev_b32 v9, 4, v0
    v_mul_u32_u24 v9, 72, v9
    s_waitcnt vmcnt(0)
    s_sleep 16
    s_mov_b32 s48, -1
    s_mov_b32 s49, 0xf
    s_mov_b64 exec, s[48:49]
    s_mov_b32 s60, 30000
Lpoll_58:
    global_load_dwordx2 v[28:29], v15, s[42:43] sc1
    global_load_dwordx2 v[30:31], v15, s[42:43] offset:2304 sc1
    s_waitcnt vmcnt(0)
    v_xor_b32 v13, s58, v29
    v_xor_b32 v14, s58, v31
    v_or_b32 v13, v13, v14
    v_cmp_ne_u32 vcc, 0, v13
    s_cbranch_vccz Lpdone_59
    s_sub_u32 s60, s60, 1
    s_cbranch_scc1 Lpdone_59
    s_sleep 4
    s_branch Lpoll_58
Lpdone_59:
    v_lshlrev_b32 v32, 16, v30
    v_and_b32 v34, 0xffff0000, v30
    v_and_b32 v30, 0xffff0000, v28
    v_lshlrev_b32 v28, 16, v28
    v_add_f32 v32, 1.0, v32
    v_add_f32 v34, 1.0, v34
    v_cvt_pk_bf16_f32 v32, v32, v32
    v_and_b32 v32, 0xffff0000, v32
    v_cvt_pk_bf16_f32 v34, v34, v34
    v_and_b32 v34, 0xffff0000, v34
    v_mul_f32 v4, v4, v32
    v_mul_f32 v5, v5, v34
    v_cvt_pk_bf16_f32 v4, v4, v4
    v_and_b32 v4, 0xffff0000, v4
    v_cvt_pk_bf16_f32 v5, v5, v5
    v_and_b32 v5, 0xffff0000, v5
    v_add_f32 v4, v4, v28
    v_add_f32 v5, v5, v30
    v_cvt_pk_bf16_f32 v4, v4, v4
    v_cvt_pk_bf16_f32 v5, v5, v5
    ds_write_b64 v12, v[4:5] offset:28672
    s_mov_b64 exec, -1
    s_waitcnt lgkmcnt(0)
    ds_read_b64 v[24:25], v9 offset:28672
    ds_read_b64 v[26:27], v9 offset:28680
    ds_read_b64 v[28:29], v9 offset:28688
    ds_read_b64 v[30:31], v9 offset:28696
    ds_read_b64 v[32:33], v9 offset:28704
    ds_read_b64 v[34:35], v9 offset:28712
    ds_read_b64 v[36:37], v9 offset:28720
    ds_read_b64 v[38:39], v9 offset:28728
    ds_read_b64 v[40:41], v9 offset:28736
    s_waitcnt lgkmcnt(0)
    v_and_b32 v48, v24, v16
    v_and_b32 v49, v24, v17
    v_and_b32 v50, v24, v18
    v_and_b32 v51, v24, v19
    v_and_b32 v52, v25, v16
    v_and_b32 v53, v25, v17
    v_and_b32 v54, v25, v18
    v_and_b32 v55, v25, v19
    v_mfma_f32_16x16x32_bf16 v[44:47], v[48:51], v[96:99], 0
    v_and_b32 v48, v26, v16
    v_and_b32 v49, v26, v17
    v_and_b32 v50, v26, v18
    v_and_b32 v51, v26, v19
    v_mfma_f32_16x16x32_bf16 v[44:47], v[52:55], v[100:103], v[44:47]
    v_and_b32 v52, v27, v16
    v_and_b32 v53, v27, v17
    v_and_b32 v54, v27, v18
    v_and_b32 v55, v27, v19
    v_mfma_f32_16x16x32_bf16 v[44:47], v[48:51], v[104:107], v[44:47]
    v_and_b32 v48, v28, v16
    v_and_b32 v49, v28, v17
    v_and_b32 v50, v28, v18
    v_and_b32 v51, v28, v19
    v_mfma_f32_16x16x32_bf16 v[44:47], v[52:55], v[108:111], v[44:47]
    v_and_b32 v52, v29, v16
    v_and_b32 v53, v29, v17
    v_and_b32 v54, v29, v18
    v_and_b32 v55, v29, v19
    v_mfma_f32_16x16x32_bf16 v[44:47], v[48:51], v[112:115], v[44:47]
    v_and_b32 v48, v30, v16
    v_and_b32 v49, v30, v17
    v_and_b32 v50, v30, v18
    v_and_b32 v51, v30, v19
    v_mfma_f32_16x16x32_bf16 v[44:47], v[52:55], v[116:119], v[44:47]
    v_and_b32 v52, v31, v16
    v_and_b32 v53, v31, v17
    v_and_b32 v54, v31, v18
    v_and_b32 v55, v31, v19
    v_mfma_f32_16x16x32_bf16 v[44:47], v[48:51], v[120:123], v[44:47]
    v_and_b32 v48, v32, v16
    v_and_b32 v49, v32, v17
    v_and_b32 v50, v32, v18
    v_and_b32 v51, v32, v19
    v_mfma_f32_16x16x32_bf16 v[44:47], v[52:55], v[124:127], v[44:47]
    v_and_b32 v52, v33, v16
    v_and_b32 v53, v33, v17
    v_and_b32 v54, v33, v18
    v_and_b32 v55, v33, v19
    v_mfma_f32_16x16x32_bf16 v[44:47], v[48:51], v[128:131], v[44:47]
    v_and_b32 v48, v34, v16
    v_and_b32 v49, v34, v17
    v_and_b32 v50, v34, v18
    v_and_b32 v51, v34, v19
    v_mfma_f32_16x16x32_bf16 v[44:47], v[52:55], v[132:135], v[44:47]
    v_and_b32 v52, v35, v16
    v_and_b32 v53, v35, v17
    v_and_b32 v54, v35, v18
    v_and_b32 v55, v35, v19
    v_mfma_f32_16x16x32_bf16 v[44:47], v[48:51], v[136:139], v[44:47]
    v_and_b32 v48, v36, v16
    v_and_b32 v49, v36, v17
    v_and_b32 v50, v36, v18
    v_and_b32 v51, v36, v19
    v_mfma_f32_16x16x32_bf16 v[44:47], v[52:55], v[140:143], v[44:47]
    v_and_b32 v52, v37, v16
    v_and_b32 v53, v37, v17
    v_and_b32 v54, v37, v18
    v_and_b32 v55, v37, v19
    v_mfma_f32_16x16x32_bf16 v[44:47], v[48:51], v[144:147], v[44:47]
    v_and_b32 v48, v38, v16
    v_and_b32 v49, v38, v17
    v_and_b32 v50, v38, v18
    v_and_b32 v51, v38, v19
    v_mfma_f32_16x16x32_bf16 v[44:47], v[52:55], v[148:151], v[44:47]
    v_and_b32 v52, v39, v16
    v_and_b32 v53, v39, v17
    v_and_b32 v54, v39, v18
    v_and_b32 v55, v39, v19
    v_mfma_f32_16x16x32_bf16 v[44:47], v[48:51], v[152:155], v[44:47]
    v_and_b32 v48, v40, v16
    v_and_b32 v49, v40, v17
    v_and_b32 v50, v40, v18
    v_and_b32 v51, v40, v19
    v_mfma_f32_16x16x32_bf16 v[44:47], v[52:55], v[156:159], v[44:47]
    v_and_b32 v52, v41, v16
    v_and_b32 v53, v41, v17
    v_and_b32 v54, v41, v18
    v_and_b32 v55, v41, v19
    v_mfma_f32_16x16x32_bf16 v[44:47], v[48:51], v[160:163], v[44:47]
    s_nop 0
    v_mfma_f32_16x16x32_bf16 v[44:47], v[52:55], v[164:167], v[44:47]
    s_nop 7
    v_mov_b32 v64, v44
    v_mov_b32 v66, v45
    v_mov_b32 v68, v46
    v_mov_b32 v70, v47
    s_mov_b32 exec_lo, -1
    s_mov_b32 exec_hi, 0
    global_store_dwordx4 v6, v[64:67], s[42:43]
    global_store_dwordx4 v6, v[68:71], s[42:43] offset:16
    global_store_dwordx4 v6, v[64:67], s[98:99] sc1
    global_store_dwordx4 v6, v[68:71], s[98:99] offset:16 sc1
    s_mov_b64 exec, -1
    s_sleep 8
    s_mov_b32 s60, 30000
    s_mov_b64 s[96:97], s[42:43]
Lpoll_60:
    global_load_dwordx4 v[24:27], v7, s[96:97] offset:-4096 sc1
    global_load_dwordx4 v[28:31], v7, s[96:97] offset:-3072 sc1
    global_load_dwordx4 v[32:35], v7, s[96:97] offset:-2048 sc1
    global_load_dwordx4 v[36:39], v7, s[96:97] offset:-1024 sc1
    global_load_dwordx4 v[40:43], v7, s[96:97] offset:0 sc1
    global_load_dwordx4 v[44:47], v7, s[96:97] offset:1024 sc1
    global_load_dwordx4 v[48:51], v7, s[96:97] offset:2048 sc1
    global_load_dwordx4 v[52:55], v7, s[96:97] offset:3072 sc1
    s_waitcnt vmcnt(0)
    v_max3_u32 v13, v25, v27, v29
    v_min3_u32 v14, v25, v27, v29
    v_max3_u32 v13, v13, v31, v33
    v_min3_u32 v14, v14, v31, v33
    v_max3_u32 v13, v13, v35, v37
    v_min3_u32 v14, v14, v35, v37
    v_max3_u32 v13, v13, v39, v41
    v_min3_u32 v14, v14, v39, v41
    v_max3_u32 v13, v13, v43, v45
    v_min3_u32 v14, v14, v43, v45
    v_max3_u32 v13, v13, v47, v49
    v_min3_u32 v14, v14, v47, v49
    v_max3_u32 v13, v13, v51, v53
    v_min3_u32 v14, v14, v51, v53
    v_max_u32 v13, v13, v55
    v_min_u32 v14, v14, v55
    v_xor_b32 v13, s58, v13
    v_xor_b32 v14, s58, v14
    v_or_b32 v13, v13, v14
    v_cmp_ne_u32 vcc, 0, v13
    s_cbranch_vccz Lpdone_61
    s_sub_u32 s60, s60, 1
    s_cbranch_scc1 Lpdone_61
    s_and_b32 s9, s60, 3
    s_cselect_b64 s[96:97], s[42:43], s[98:99]
    s_sleep 2
    s_branch Lpoll_60
Lpdone_61:
    v_add_f32 v24, v24, v28
    v_add_f32 v26, v26, v30
    v_add_f32 v32, v32, v36
    v_add_f32 v34, v34, v38
    v_add_f32 v40, v40, v44
    v_add_f32 v42, v42, v46
    v_add_f32 v48, v48, v52
    v_add_f32 v50, v50, v54
    v_add_f32 v24, v24, v32
    v_add_f32 v26, v26, v34
    v_add_f32 v40, v40, v48
    v_add_f32 v42, v42, v50
    v_add_f32 v24, v24, v40
    v_add_f32 v26, v26, v42
    v_cvt_pk_bf16_f32 v24, v24, v26
    v_mov_b32 v25, 1
    ds_write_b32 v8, v24 offset:256
    ds_write_b32 v23, v25 offset:12
    s_lshl_b32 s9, s6, 4
    s_add_u32 s9, s9, 196608
    v_mov_b32 v3, s9
    v_and_b32 v12, 31, v0
    v_lshlrev_b32 v12, 3, v12
    v_and_b32 v13, 7, v0
    v_lshlrev_b32 v13, 4, v13
    s_lshl_b32 s9, s7, 7
    s_add_u32 s9, s9, 196608
    v_add_u32 v13, s9, v13
    s_mov_b32 s60, 300000
Lspin_62:
    ds_read_b32 v14, v23 offset:0
    s_waitcnt lgkmcnt(0)
    v_readfirstlane_b32 s9, v14
    s_nop 0
    s_cmp_ge_u32 s9, 8
    s_cbranch_scc1 Lsdone_63
    s_sub_u32 s60, s60, 1
    s_cbranch_scc1 Lsdone_63
    s_sleep 2
    s_branch Lspin_62
Lsdone_63:
    ds_read_b64 v[24:25], v12 offset:512
    v_mov_b32 v66, s58
    s_waitcnt lgkmcnt(0)
    v_mov_b32 v64, v24
    s_nop 1
    v_max_f32_dpp v64, v64, v64 row_ror:8 row_mask:0xf bank_mask:0xf
    s_nop 1
    v_max_f32_dpp v64, v64, v64 row_ror:4 row_mask:0xf bank_mask:0xf
    s_nop 1
    v_max_f32_dpp v64, v64, v64 row_ror:2 row_mask:0xf bank_mask:0xf
    s_nop 1
    v_max_f32_dpp v64, v64, v64 row_ror:1 row_mask:0xf bank_mask:0xf
    v_mov_b32 v27, v64
    s_nop 1
    v_permlane16_swap_b32 v64, v27
    v_max_f32 v64, v64, v27
    v_sub_f32 v24, v24, v64
    v_mul_f32 v24, 0x3fb8aa3b, v24
    v_exp_f32 v24, v24
    s_nop 0
    v_mul_f32 v65, v24, v25
    s_nop 1
    v_add_f32_dpp v65, v65, v65 row_ror:8 row_mask:0xf bank_mask:0xf
    s_nop 1
    v_add_f32_dpp v65, v65, v65 row_ror:4 row_mask:0xf bank_mask:0xf
    s_nop 1
    v_add_f32_dpp v65, v65, v65 row_ror:2 row_mask:0xf bank_mask:0xf
    s_nop 1
    v_add_f32_dpp v65, v65, v65 row_ror:1 row_mask:0xf bank_mask:0xf
    v_mov_b32 v24, v65
    s_nop 1
    v_permlane16_swap_b32 v65, v24
    v_add_f32 v65, v65, v24
    s_mov_b64 exec, 1
    global_store_dwordx4 v3, v[64:67], s[42:43]
    global_store_dwordx4 v3, v[64:67], s[98:99] sc1
    s_mov_b64 exec, -1
    s_sleep 12
    s_mov_b32 s60, 30000
    s_mov_b64 s[96:97], s[42:43]
Lpoll_64:
    global_load_dwordx4 v[28:31], v13, s[96:97] sc1
    s_waitcnt vmcnt(0)
    v_xor_b32 v14, s58, v30
    v_xor_b32 v15, s58, v31
    v_or_b32 v14, v14, v15
    v_cmp_ne_u32 vcc, 0, v14
    s_cbranch_vccz Lpdone_65
    s_sub_u32 s60, s60, 1
    s_cbranch_scc1 Lpdone_65
    s_and_b32 s9, s60, 3
    s_cselect_b64 s[96:97], s[42:43], s[98:99]
    s_sleep 2
    s_branch Lpoll_64
Lpdone_65:
    v_mov_b32 v26, v28
    s_nop 1
    v_max_f32_dpp v26, v26, v26 quad_perm:[1,0,3,2] row_mask:0xf bank_mask:0xf
    s_nop 1
    v_max_f32_dpp v26, v26, v26 quad_perm:[2,3,0,1] row_mask:0xf bank_mask:0xf
    s_nop 1
    v_max_f32_dpp v26, v26, v26 row_half_mirror row_mask:0xf bank_mask:0xf
    v_sub_f32 v24, v28, v26
    v_mul_f32 v24, 0x3fb8aa3b, v24
    v_exp_f32 v24, v24
    s_nop 0
    v_mul_f32 v27, v24, v29
    s_nop 1
    v_add_f32_dpp v27, v27, v27 quad_perm:[1,0,3,2] row_mask:0xf bank_mask:0xf
    s_nop 1
    v_add_f32_dpp v27, v27, v27 quad_perm:[2,3,0,1] row_mask:0xf bank_mask:0xf
    s_nop 1
    v_add_f32_dpp v27, v27, v27 row_half_mirror row_mask:0xf bank_mask:0xf
    v_rcp_f32 v27, v27
    v_mov_b32 v24, 1
    s_mov_b64 exec, 1
    ds_write_b64 v23, v[26:27] offset:32
    ds_write_b32 v23, v24 offset:4
    s_mov_b64 exec, -1
    s_branch L_tail_loads
L_s2:
L_s1:
    s_cmp_ge_u32 s5, 27
    s_cbranch_scc1 L_mblk
    s_waitcnt lgkmcnt(0)
    s_load_dword s58, s[42:43], 245760
    s_add_u32 s98, s42, 33554432
    s_addc_u32 s99, s43, 0
    s_mov_b64 s[96:97], s[42:43]
    s_barrier
    s_waitcnt lgkmcnt(0)
    s_add_u32 s58, s58, 1
    s_branch L_tail_loads
L_mblk:
    s_sub_u32 s12, s2, 216
    s_sub_u32 s11, s3, 1
    s_mov_b32 s15, 2
    s_mul_i32 s9, s11, 384
    v_lshl_add_u32 v9, v0, 1, s9
    s_mul_i32 s9, s11, 768
    s_add_u32 s9, s9, 23552
    v_lshrrev_b32 v13, 3, v0
    v_mul_u32_u24 v13, 96, v13
    v_add_u32 v13, s9, v13
    v_lshl_add_u32 v12, v0, 2, s9
    v_lshrrev_b32 v8, 3, v0
    v_mul_u32_u24 v8, 24, v8
    s_mul_i32 s9, s11, 192
    v_add_u32 v8, s9, v8
    v_mul_u32_u24 v8, 6912, v8
    v_and_b32 v10, 7, v0
    v_lshl_add_u32 v8, v10, 4, v8
    s_lshl_b32 s9, s12, 7
    v_add_u32 v8, s9, v8
    s_waitcnt lgkmcnt(0)
    global_load_ushort v4, v9, s[34:35] offset:0
    global_load_ushort v5, v9, s[34:35] offset:128
    global_load_ushort v6, v9, s[34:35] offset:256
    s_mov_b64 vcc, -1
    s_cmp_lt_u32 s12, 18
    s_cbranch_scc1 L_mb_go
    s_barrier
L_mb_rest:
    s_mov_b32 s60, 300000
Lspin_66:
    ds_read_b32 v14, v23 offset:0
    s_waitcnt lgkmcnt(0)
    v_readfirstlane_b32 s9, v14
    s_nop 0
    s_cmp_ge_u32 s9, 8
    s_cbranch_scc1 Lsdone_67
    s_sub_u32 s60, s60, 1
    s_cbranch_scc1 Lsdone_67
    s_sleep 2
    s_branch Lspin_66
Lsdone_67:
    s_mov_b64 vcc, 0
L_mb_go:
    v_mov_b32 v11, v8
    global_load_dwordx4 v[72:75], v11, s[36:37] nt
    v_add_u32 v11, 6912, v11
    global_load_dwordx4 v[76:79], v11, s[36:37] nt
    v_add_u32 v11, 6912, v11
    global_load_dwordx4 v[80:83], v11, s[36:37] nt
    v_add_u32 v11, 6912, v11
    global_load_dwordx4 v[84:87], v11, s[36:37] nt
    v_add_u32 v11, 6912, v11
    global_load_dwordx4 v[88:91], v11, s[36:37] nt
    v_add_u32 v11, 6912, v11
    global_load_dwordx4 v[92:95], v11, s[36:37] nt
    v_add_u32 v11, 6912, v11
    global_load_dwordx4 v[96:99], v11, s[36:37] nt
    v_add_u32 v11, 6912, v11
    global_load_dwordx4 v[100:103], v11, s[36:37] nt
    v_add_u32 v11, 6912, v11
    s_cbranch_vccnz Lmt_68
    s_waitcnt vmcnt(7)
Lmt_68:
    global_load_dwordx4 v[104:107], v11, s[36:37] nt
    v_add_u32 v11, 6912, v11
    s_cbranch_vccnz Lmt_69
    s_waitcnt vmcnt(7)
Lmt_69:
    global_load_dwordx4 v[108:111], v11, s[36:37] nt
    v_add_u32 v11, 6912, v11
    s_cbranch_vccnz Lmt_70
    s_waitcnt vmcnt(7)
Lmt_70:
    global_load_dwordx4 v[112:115], v11, s[36:37] nt
    v_add_u32 v11, 6912, v11
    s_cbranch_vccnz Lmt_71
    s_waitcnt vmcnt(7)
Lmt_71:
    global_load_dwordx4 v[116:119], v11, s[36:37] nt
    v_add_u32 v11, 6912, v11
    s_cbranch_vccnz Lmt_72
    s_waitcnt vmcnt(7)
Lmt_72:
    global_load_dwordx4 v[120:123], v11, s[36:37] nt
    v_add_u32 v11, 6912, v11
    s_cbranch_vccnz Lmt_73
    s_waitcnt vmcnt(7)
Lmt_73:
    global_load_dwordx4 v[124:127], v11, s[36:37] nt
    v_add_u32 v11, 6912, v11
    s_cbranch_vccnz Lmt_74
    s_waitcnt vmcnt(7)
Lmt_74:
    global_load_dwordx4 v[128:131], v11, s[36:37] nt
    v_add_u32 v11, 6912, v11
    s_cbranch_vccnz Lmt_75
    s_waitcnt vmcnt(7)
Lmt_75:
    global_load_dwordx4 v[132:135], v11, s[36:37] nt
    v_add_u32 v11, 6912, v11
    s_cbranch_vccnz Lmt_76
    s_waitcnt vmcnt(7)
Lmt_76:
    global_load_dwordx4 v[136:139], v11, s[36:37] nt
    v_add_u32 v11, 6912, v11
    s_cbranch_vccnz Lmt_77
    s_waitcnt vmcnt(7)
Lmt_77:
    global_load_dwordx4 v[140:143], v11, s[36:37] nt
    v_add_u32 v11, 6912, v11
    s_cbranch_vccnz Lmt_78
    s_waitcnt vmcnt(7)
Lmt_78:
    global_load_dwordx4 v[144:147], v11, s[36:37] nt
    v_add_u32 v11, 6912, v11
    s_cbranch_vccnz Lmt_79
    s_waitcnt vmcnt(7)
Lmt_79:
    global_load_dwordx4 v[148:151], v11, s[36:37] nt
    v_add_u32 v11, 6912, v11
    s_cbranch_vccnz Lmt_80
    s_waitcnt vmcnt(7)
Lmt_80:
    global_load_dwordx4 v[152:155], v11, s[36:37] nt
    v_add_u32 v11, 6912, v11
    s_cbranch_vccnz Lmt_81
    s_waitcnt vmcnt(7)
Lmt_81:
    global_load_dwordx4 v[156:159], v11, s[36:37] nt
    v_add_u32 v11, 6912, v11
    s_cbranch_vccnz Lmt_82
    s_waitcnt vmcnt(7)
Lmt_82:
    global_load_dwordx4 v[160:163], v11, s[36:37] nt
    v_add_u32 v11, 6912, v11
    s_cbranch_vccnz Lmt_83
    s_waitcnt vmcnt(7)
Lmt_83:
    global_load_dwordx4 v[164:167], v11, s[36:37] nt
    s_cmp_lg_u32 s15, 2
    s_cbranch_scc1 L_mb_2nd
    s_load_dword s58, s[42:43], 245760
    s_add_u32 s98, s42, 33554432
    s_addc_u32 s99, s43, 0
    s_mov_b64 s[96:97], s[42:43]
    s_cmp_ge_u32 s12, 18
    s_cbranch_scc1 L_mb_nb
    s_barrier
L_mb_nb:
    v_and_b32 v14, 1, v0
    v_lshlrev_b32 v14, 4, v14
    v_mov_b32 v15, 0xffff
    v_lshlrev_b32 v15, v14, v15
    v_and_b32 v14, 7, v0
    v_lshrrev_b32 v14, 1, v14
    v_cmp_eq_u32 vcc, 0, v14
    s_nop 1
    v_cndmask_b32 v16, 0, v15, vcc
    v_cmp_eq_u32 vcc, 1, v14
    s_nop 1
    v_cndmask_b32 v17, 0, v15, vcc
    v_cmp_eq_u32 vcc, 2, v14
    s_nop 1
    v_cndmask_b32 v18, 0, v15, vcc
    v_cmp_eq_u32 vcc, 3, v14
    s_nop 1
    v_cndmask_b32 v19, 0, v15, vcc
    v_and_b32 v10, 7, v0
    v_lshlrev_b32 v10, 5, v10
    v_lshrrev_b32 v14, 4, v0
    v_lshl_add_u32 v10, v14, 4, v10
    s_lshl_b32 s9, s11, 8
    v_add_u32 v10, s9, v10
    v_lshlrev_b32 v2, 3, v0
    v_mov_b32 v7, 1
    s_waitcnt lgkmcnt(0)
    s_add_u32 s58, s58, 1
    v_mov_b32 v61, s58
    s_waitcnt vmcnt(24)
    v_lshlrev_b32 v4, 16, v4
    v_lshlrev_b32 v5, 16, v5
    v_lshlrev_b32 v6, 16, v6
    v_mul_f32 v28, 0xbfb8aa3b, v4
    v_exp_f32 v28, v28
    s_nop 0
    v_add_f32 v28, 1.0, v28
    v_rcp_f32 v28, v28
    s_nop 0
    v_mul_f32 v4, v4, v28
    v_mul_f32 v29, 0xbfb8aa3b, v5
    v_exp_f32 v29, v29
    s_nop 0
    v_add_f32 v29, 1.0, v29
    v_rcp_f32 v29, v29
    s_nop 0
    v_mul_f32 v5, v5, v29
    v_mul_f32 v30, 0xbfb8aa3b, v6
    v_exp_f32 v30, v30
    s_nop 0
    v_add_f32 v30, 1.0, v30
    v_rcp_f32 v30, v30
    s_nop 0
    v_mul_f32 v6, v6, v30
    v_cvt_pk_bf16_f32 v4, v4, v4
    v_cvt_pk_bf16_f32 v5, v5, v5
    v_cvt_pk_bf16_f32 v6, v6, v6
    ds_write2st64_b32 v12, v4, v5 offset0:0 offset1:1
    ds_write_b32 v12, v6 offset:512
    s_waitcnt lgkmcnt(0)
    ds_read_b128 v[24:27], v13 offset:0
    ds_read_b128 v[28:31], v13 offset:16
    ds_read_b128 v[32:35], v13 offset:32
    ds_read_b128 v[36:39], v13 offset:48
    ds_read_b128 v[40:43], v13 offset:64
    ds_read_b128 v[44:47], v13 offset:80
L_mb_2nd:
    s_lshl_b32 s9, s12, 8
    s_add_u32 s9, s9, 0
    v_add_u32 v3, s9, v2
    s_waitcnt lgkmcnt(0) vmcnt(0)
    v_and_b32 v52, v24, v16
    v_and_b32 v53, v24, v17
    v_and_b32 v54, v24, v18
    v_and_b32 v55, v24, v19
    v_and_b32 v56, v25, v16
    v_and_b32 v57, v25, v17
    v_and_b32 v58, v25, v18
    v_and_b32 v59, v25, v19
    v_mfma_f32_16x16x32_bf16 v[48:51], v[52:55], v[72:75], 0
    v_and_b32 v52, v26, v16
    v_and_b32 v53, v26, v17
    v_and_b32 v54, v26, v18
    v_and_b32 v55, v26, v19
    v_mfma_f32_16x16x32_bf16 v[48:51], v[56:59], v[76:79], v[48:51]
    v_and_b32 v56, v27, v16
    v_and_b32 v57, v27, v17
    v_and_b32 v58, v27, v18
    v_and_b32 v59, v27, v19
    v_mfma_f32_16x16x32_bf16 v[48:51], v[52:55], v[80:83], v[48:51]
    v_and_b32 v52, v28, v16
    v_and_b32 v53, v28, v17
    v_and_b32 v54, v28, v18
    v_and_b32 v55, v28, v19
    v_mfma_f32_16x16x32_bf16 v[48:51], v[56:59], v[84:87], v[48:51]
    v_and_b32 v56, v29, v16
    v_and_b32 v57, v29, v17
    v_and_b32 v58, v29, v18
    v_and_b32 v59, v29, v19
    v_mfma_f32_16x16x32_bf16 v[48:51], v[52:55], v[88:91], v[48:51]
    v_and_b32 v52, v30, v16
    v_and_b32 v53, v30, v17
    v_and_b32 v54, v30, v18
    v_and_b32 v55, v30, v19
    v_mfma_f32_16x16x32_bf16 v[48:51], v[56:59], v[92:95], v[48:51]
    v_and_b32 v56, v31, v16
    v_and_b32 v57, v31, v17
    v_and_b32 v58, v31, v18
    v_and_b32 v59, v31, v19
    v_mfma_f32_16x16x32_bf16 v[48:51], v[52:55], v[96:99], v[48:51]
    v_and_b32 v52, v32, v16
    v_and_b32 v53, v32, v17
    v_and_b32 v54, v32, v18
    v_and_b32 v55, v32, v19
    v_mfma_f32_16x16x32_bf16 v[48:51], v[56:59], v[100:103], v[48:51]
    v_and_b32 v56, v33, v16
    v_and_b32 v57, v33, v17
    v_and_b32 v58, v33, v18
    v_and_b32 v59, v33, v19
    v_mfma_f32_16x16x32_bf16 v[48:51], v[52:55], v[104:107], v[48:51]
    v_and_b32 v52, v34, v16
    v_and_b32 v53, v34, v17
    v_and_b32 v54, v34, v18
    v_and_b32 v55, v34, v19
    v_mfma_f32_16x16x32_bf16 v[48:51], v[56:59], v[108:111], v[48:51]
    v_and_b32 v56, v35, v16
    v_and_b32 v57, v35, v17
    v_and_b32 v58, v35, v18
    v_and_b32 v59, v35, v19
    v_mfma_f32_16x16x32_bf16 v[48:51], v[52:55], v[112:115], v[48:51]
    v_and_b32 v52, v36, v16
    v_and_b32 v53, v36, v17
    v_and_b32 v54, v36, v18
    v_and_b32 v55, v36, v19
    v_mfma_f32_16x16x32_bf16 v[48:51], v[56:59], v[116:119], v[48:51]
    v_and_b32 v56, v37, v16
    v_and_b32 v57, v37, v17
    v_and_b32 v58, v37, v18
    v_and_b32 v59, v37, v19
    v_mfma_f32_16x16x32_bf16 v[48:51], v[52:55], v[120:123], v[48:51]
    v_and_b32 v52, v38, v16
    v_and_b32 v53, v38, v17
    v_and_b32 v54, v38, v18
    v_and_b32 v55, v38, v19
    v_mfma_f32_16x16x32_bf16 v[48:51], v[56:59], v[124:127], v[48:51]
    v_and_b32 v56, v39, v16
    v_and_b32 v57, v39, v17
    v_and_b32 v58, v39, v18
    v_and_b32 v59, v39, v19
    v_mfma_f32_16x16x32_bf16 v[48:51], v[52:55], v[128:131], v[48:51]
    v_and_b32 v52, v40, v16
    v_and_b32 v53, v40, v17
    v_and_b32 v54, v40, v18
    v_and_b32 v55, v40, v19
    v_mfma_f32_16x16x32_bf16 v[48:51], v[56:59], v[132:135], v[48:51]
    v_and_b32 v56, v41, v16
    v_and_b32 v57, v41, v17
    v_and_b32 v58, v41, v18
    v_and_b32 v59, v41, v19
    v_mfma_f32_16x16x32_bf16 v[48:51], v[52:55], v[136:139], v[48:51]
    v_and_b32 v52, v42, v16
    v_and_b32 v53, v42, v17
    v_and_b32 v54, v42, v18
    v_and_b32 v55, v42, v19
    v_mfma_f32_16x16x32_bf16 v[48:51], v[56:59], v[140:143], v[48:51]
    v_and_b32 v56, v43, v16
    v_and_b32 v57, v43, v17
    v_and_b32 v58, v43, v18
    v_and_b32 v59, v43, v19
    v_mfma_f32_16x16x32_bf16 v[48:51], v[52:55], v[144:147], v[48:51]
    v_and_b32 v52, v44, v16
    v_and_b32 v53, v44, v17
    v_and_b32 v54, v44, v18
    v_and_b32 v55, v44, v19
    v_mfma_f32_16x16x32_bf16 v[48:51], v[56:59], v[148:151], v[48:51]
    v_and_b32 v56, v45, v16
    v_and_b32 v57, v45, v17
    v_and_b32 v58, v45, v18
    v_and_b32 v59, v45, v19
    v_mfma_f32_16x16x32_bf16 v[48:51], v[52:55], v[152:155], v[48:51]
    v_and_b32 v52, v46, v16
    v_and_b32 v53, v46, v17
    v_and_b32 v54, v46, v18
    v_and_b32 v55, v46, v19
    v_mfma_f32_16x16x32_bf16 v[48:51], v[56:59], v[156:159], v[48:51]
    v_and_b32 v56, v47, v16
    v_and_b32 v57, v47, v17
    v_and_b32 v58, v47, v18
    v_and_b32 v59, v47, v19
    v_mfma_f32_16x16x32_bf16 v[48:51], v[52:55], v[160:163], v[48:51]
    s_nop 0
    v_mfma_f32_16x16x32_bf16 v[48:51], v[56:59], v[164:167], v[48:51]
    s_nop 7
    v_mov_b32 v52, v48
    v_mov_b32 v53, v49
    v_mov_b32 v54, v50
    v_mov_b32 v55, v51
    v_permlane32_swap_b32 v48, v52
    v_permlane32_swap_b32 v49, v53
    v_permlane32_swap_b32 v50, v54
    v_permlane32_swap_b32 v51, v55
    v_add_f32_dpp v48, v52, v48 row_ror:8 row_mask:0xf bank_mask:0xf
    v_add_f32_dpp v49, v53, v49 row_ror:8 row_mask:0xf bank_mask:0xf
    v_add_f32_dpp v50, v54, v50 row_ror:8 row_mask:0xf bank_mask:0xf
    v_add_f32_dpp v51, v55, v51 row_ror:8 row_mask:0xf bank_mask:0xf
    s_mov_b64 exec, 0x00ff00ff
    ds_write_b128 v10, v[48:51] offset:26624
    s_mov_b64 exec, 1
    ds_add_rtn_u32 v14, v23, v7 offset:28
    s_mov_b64 exec, -1
    s_waitcnt lgkmcnt(0)
    v_readfirstlane_b32 s9, v14
    s_nop 0
    s_cmp_lg_u32 s9, s15
    s_cbranch_scc1 L_mb_np
    s_sub_u32 s9, s15, 2
    s_lshl_b32 s9, s9, 8
    v_add_u32 v14, s9, v2
    s_mov_b32 exec_lo, -1
    s_mov_b32 exec_hi, 0
    ds_read_b64 v[48:49], v14 offset:26624
    ds_read_b64 v[50:51], v14 offset:26880
    ds_read_b64 v[52:53], v14 offset:27136
    s_waitcnt lgkmcnt(0)
    v_add_f32 v48, v48, v50
    v_add_f32 v49, v49, v51
    v_add_f32 v48, v48, v52
    v_add_f32 v49, v49, v53
    v_cvt_pk_bf16_f32 v60, v48, v49
    global_store_dwordx2 v3, v[60:61], s[42:43] sc1
    s_mov_b64 exec, -1
L_mb_np:
    s_cmp_ge_u32 s12, 18
    s_cbranch_scc1 L_end
    s_mov_b32 s15, 5
    v_add_u32 v10, 768, v10
    s_cmp_ge_u32 s12, 9
    s_cbranch_scc1 L_mb_gb
    s_and_b32 s9, s12, 1
    s_cbranch_scc1 L_end
    s_lshr_b32 s9, s12, 1
    s_sub_u32 s9, 40, s9
    s_add_u32 s12, s12, s9
    s_lshl_b32 s9, s9, 7
    v_add_u32 v8, s9, v8
    s_branch L_mb_rest
L_mb_gb:
    s_add_u32 s12, s12, 36
    v_add_u32 v8, 4608, v8
    s_mov_b32 s60, 300000
Lspin_84:
    ds_read_b32 v14, v23 offset:20
    s_waitcnt lgkmcnt(0)
    v_readfirstlane_b32 s9, v14
    s_nop 0
    s_cmp_ge_u32 s9, 1
    s_cbranch_scc1 Lsdone_85
    s_sub_u32 s60, s60, 1
    s_cbranch_scc1 Lsdone_85
    s_sleep 2
    s_branch Lspin_84
Lsdone_85:
    s_mov_b64 vcc, -1
    s_branch L_mb_go
L_s3:
    v_lshlrev_b32 v2, 2, v0
    s_mov_b64 exec, 0xffff
    ds_write_b32 v2, v23
    s_mov_b64 exec, -1
    s_cmp_ge_u32 s5, 27
    s_cbranch_scc1 L_mblk
    v_mov_b32 v4, -1
    v_mov_b32 v5, -1
    v_mov_b32 v6, -1
    v_mov_b32 v7, -1
    s_mul_i32 s9, s10, 2304
    s_add_u32 s9, s9, 458752
    v_add_u32 v3, s9, v1
    s_mul_i32 s9, s4, 2304
    s_sub_u32 s11, s5, 18
    s_lshl_b32 s11, s11, 8
    s_add_u32 s9, s9, s11
    s_add_u32 s9, s9, 393216
    v_add_u32 v8, s9, v1
    s_lshl_b32 s9, s2, 2
    s_add_u32 s9, s9, 229376
    v_mov_b32 v9, s9
    s_waitcnt lgkmcnt(0)
    s_load_dword s58, s[42:43], 245760
    s_add_u32 s98, s42, 33554432
    s_addc_u32 s99, s43, 0
    s_mov_b64 s[96:97], s[42:43]
    s_barrier
    s_mov_b32 s60, 300000
Lspin_86:
    ds_read_b32 v14, v23 offset:12
    s_waitcnt lgkmcnt(0)
    v_readfirstlane_b32 s9, v14
    s_nop 0
    s_cmp_ge_u32 s9, 1
    s_cbranch_scc1 Lsdone_87
    s_sub_u32 s60, s60, 1
    s_cbranch_scc1 Lsdone_87
    s_sleep 2
    s_branch Lspin_86
Lsdone_87:
    s_cmp_ge_u32 s5, 18
    s_cbranch_scc1 L_s3_nf
    global_store_dwordx4 v3, v[4:7], s[42:43] sc1
    global_store_dwordx4 v3, v[4:7], s[42:43] offset:1024 sc1
    s_mov_b64 exec, 0xffff
    global_store_dwordx4 v3, v[4:7], s[42:43] offset:2048 sc1
    s_mov_b64 exec, -1
    s_branch L_s3_nw
L_s3_nf:
    s_mov_b64 exec, 0xffff
    global_store_dwordx4 v8, v[4:7], s[42:43] sc1
    s_mov_b64 exec, -1
L_s3_nw:
    s_add_u32 s58, s58, 1
    v_mov_b32 v10, s58
    s_waitcnt vmcnt(0)
    s_mov_b64 exec, 1
    global_store_dword v9, v10, s[42:43] sc1
    s_mov_b64 exec, -1
L_tail_loads:
    s_cmp_ge_u32 s5, 27
    s_cbranch_scc1 L_s_idle
    v_and_b32 v14, 1, v0
    v_lshlrev_b32 v14, 4, v14
    v_mov_b32 v15, 0xffff
    v_lshlrev_b32 v15, v14, v15
    v_and_b32 v14, 7, v0
    v_lshrrev_b32 v14, 1, v14
    v_cmp_eq_u32 vcc, 0, v14
    s_nop 1
    v_cndmask_b32 v16, 0, v15, vcc
    v_cmp_eq_u32 vcc, 1, v14
    s_nop 1
    v_cndmask_b32 v17, 0, v15, vcc
    v_cmp_eq_u32 vcc, 2, v14
    s_nop 1
    v_cndmask_b32 v18, 0, v15, vcc
    v_cmp_eq_u32 vcc, 3, v14
    s_nop 1
    v_cndmask_b32 v19, 0, v15, vcc
    s_cmp_ge_u32 s5, 18
    s_cbranch_scc1 L_w
    v_lshrrev_b32 v8, 3, v0
    v_mul_u32_u24 v8, 18, v8
    s_mul_i32 s9, s3, 144
    v_add_u32 v8, s9, v8
    v_mul_u32_u24 v8, 9216, v8
    v_and_b32 v9, 3, v0
    v_lshl_add_u32 v8, v9, 4, v8
    s_lshl_b32 s9, s10, 6
    v_add_u32 v8, s9, v8
    v_and_b32 v9, 4, v0
    v_cmp_ne_u32 vcc, 0, v9
    v_mov_b32 v10, s28
    v_mov_b32 v11, s30
    v_cndmask_b32 v10, v10, v11, vcc
    v_mov_b32 v11, s29
    v_mov_b32 v12, s31
    v_cndmask_b32 v11, v11, v12, vcc
    v_add_co_u32 v10, vcc, v10, v8
    s_nop 1
    v_addc_co_u32 v11, vcc, 0, v11, vcc
    s_mov_b32 s50, 9216
    s_mov_b32 s51, 0
    v_lshrrev_b32 v8, 3, v0
    v_lshlrev_b32 v8, 2, v8
    s_lshl_b32 s9, s10, 5
    v_add_u32 v8, s9, v8
    v_mul_u32_u24 v8, 1152, v8
    v_and_b32 v9, 7, v0
    v_lshl_add_u32 v8, v9, 4, v8
    s_mul_i32 s9, s3, 384
    v_add_u32 v8, s9, v8
    s_mov_b32 s60, 300000
Lspin_88:
    ds_read_b32 v14, v23 offset:0
    s_waitcnt lgkmcnt(0)
    v_readfirstlane_b32 s9, v14
    s_nop 0
    s_cmp_ge_u32 s9, 8
    s_cbranch_scc1 Lsdone_89
    s_sub_u32 s60, s60, 1
    s_cbranch_scc1 Lsdone_89
    s_sleep 2
    s_branch Lspin_88
Lsdone_89:
    global_load_dwordx4 v[96:99], v[10:11], off nt
    v_lshl_add_u64 v[10:11], v[10:11], 0, s[50:51]
    global_load_dwordx4 v[100:103], v[10:11], off nt
    v_lshl_add_u64 v[10:11], v[10:11], 0, s[50:51]
    s_waitcnt vmcnt(1)
    global_load_dwordx4 v[104:107], v[10:11], off nt
    v_lshl_add_u64 v[10:11], v[10:11], 0, s[50:51]
    s_waitcnt vmcnt(1)
    global_load_dwordx4 v[108:111], v[10:11], off nt
    v_lshl_add_u64 v[10:11], v[10:11], 0, s[50:51]
    s_waitcnt vmcnt(1)
    global_load_dwordx4 v[112:115], v[10:11], off nt
    v_lshl_add_u64 v[10:11], v[10:11], 0, s[50:51]
    s_waitcnt vmcnt(1)
    global_load_dwordx4 v[116:119], v[10:11], off nt
    v_lshl_add_u64 v[10:11], v[10:11], 0, s[50:51]
    s_waitcnt vmcnt(1)
    global_load_dwordx4 v[120:123], v[10:11], off nt
    v_lshl_add_u64 v[10:11], v[10:11], 0, s[50:51]
    s_waitcnt vmcnt(1)
    global_load_dwordx4 v[124:127], v[10:11], off nt
    v_lshl_add_u64 v[10:11], v[10:11], 0, s[50:51]
    s_waitcnt vmcnt(1)
    global_load_dwordx4 v[128:131], v[10:11], off nt
    v_lshl_add_u64 v[10:11], v[10:11], 0, s[50:51]
    s_waitcnt vmcnt(1)
    global_load_dwordx4 v[132:135], v[10:11], off nt
    v_lshl_add_u64 v[10:11], v[10:11], 0, s[50:51]
    s_waitcnt vmcnt(1)
    global_load_dwordx4 v[136:139], v[10:11], off nt
    v_lshl_add_u64 v[10:11], v[10:11], 0, s[50:51]
    s_waitcnt vmcnt(1)
    global_load_dwordx4 v[140:143], v[10:11], off nt
    v_lshl_add_u64 v[10:11], v[10:11], 0, s[50:51]
    s_waitcnt vmcnt(1)
    global_load_dwordx4 v[144:147], v[10:11], off nt
    v_lshl_add_u64 v[10:11], v[10:11], 0, s[50:51]
    s_waitcnt vmcnt(1)
    global_load_dwordx4 v[148:151], v[10:11], off nt
    v_lshl_add_u64 v[10:11], v[10:11], 0, s[50:51]
    s_waitcnt vmcnt(1)
    global_load_dwordx4 v[152:155], v[10:11], off nt
    v_lshl_add_u64 v[10:11], v[10:11], 0, s[50:51]
    s_cmp_lg_u32 s3, 3
    s_cbranch_scc1 L_f_e3
    s_waitcnt vmcnt(1)
    global_load_dwordx4 v[156:159], v[10:11], off nt
    v_lshl_add_u64 v[10:11], v[10:11], 0, s[50:51]
    s_waitcnt vmcnt(1)
    global_load_dwordx4 v[160:163], v[10:11], off nt
    v_lshl_add_u64 v[10:11], v[10:11], 0, s[50:51]
    s_waitcnt vmcnt(1)
    global_load_dwordx4 v[164:167], v[10:11], off nt
L_f_e3:
    s_cmp_lg_u32 s3, 2
    s_cbranch_scc1 L_nomf
    s_mov_b32 s60, 300000
Lspin_90:
    ds_read_b32 v14, v23 offset:8
    s_waitcnt lgkmcnt(0)
    v_readfirstlane_b32 s9, v14
    s_nop 0
    s_cmp_ge_u32 s9, 8
    s_cbranch_scc1 Lsdone_91
    s_sub_u32 s60, s60, 1
    s_cbranch_scc1 Lsdone_91
    s_sleep 2
    s_branch Lspin_90
Lsdone_91:
    v_add_u32 v15, 7680, v1
    v_mov_b32 v48, s58
    v_mov_b32 v49, s58
    v_mov_b32 v50, s58
    v_mov_b32 v51, s58
    s_mov_b32 s60, 30000
Lpoll_92:
    global_load_dwordx4 v[24:27], v15, s[42:43] offset:-3072 sc1
    global_load_dwordx4 v[28:31], v15, s[42:43] offset:-2048 sc1
    global_load_dwordx4 v[32:35], v15, s[42:43] offset:-1024 sc1
    global_load_dwordx4 v[36:39], v15, s[42:43] offset:0 sc1
    global_load_dwordx4 v[40:43], v15, s[42:43] offset:1024 sc1
    global_load_dwordx4 v[44:47], v15, s[42:43] offset:2048 sc1
    s_mov_b32 exec_hi, 0xffff
    global_load_dwordx4 v[48:51], v15, s[42:43] offset:3072 sc1
    s_mov_b32 exec_hi, -1
    s_waitcnt vmcnt(0)
    v_max3_u32 v13, v25, v27, v29
    v_min3_u32 v14, v25, v27, v29
    v_max3_u32 v13, v13, v31, v33
    v_min3_u32 v14, v14, v31, v33
    v_max3_u32 v13, v13, v35, v37
    v_min3_u32 v14, v14, v35, v37
    v_max3_u32 v13, v13, v39, v41
    v_min3_u32 v14, v14, v39, v41
    v_max3_u32 v13, v13, v43, v45
    v_min3_u32 v14, v14, v43, v45
    v_max3_u32 v13, v13, v47, v49
    v_min3_u32 v14, v14, v47, v49
    v_max_u32 v13, v13, v51
    v_min_u32 v14, v14, v51
    v_xor_b32 v13, s58, v13
    v_xor_b32 v14, s58, v14
    v_or_b32 v13, v13, v14
    v_cmp_ne_u32 vcc, 0, v13
    s_cbranch_vccz Lpdone_93
    s_sub_u32 s60, s60, 1
    s_cbranch_scc1 Lpdone_93
    s_sleep 16
    s_branch Lpoll_92
Lpdone_93:
    v_and_b32 v27, 0xffff0000, v26
    v_lshlrev_b32 v26, 16, v26
    v_and_b32 v25, 0xffff0000, v24
    v_lshlrev_b32 v24, 16, v24
    ds_write_b128 v1, v[24:27] offset:12032
    v_and_b32 v31, 0xffff0000, v30
    v_lshlrev_b32 v30, 16, v30
    v_and_b32 v29, 0xffff0000, v28
    v_lshlrev_b32 v28, 16, v28
    ds_write_b128 v1, v[28:31] offset:13056
    v_and_b32 v35, 0xffff0000, v34
    v_lshlrev_b32 v34, 16, v34
    v_and_b32 v33, 0xffff0000, v32
    v_lshlrev_b32 v32, 16, v32
    ds_write_b128 v1, v[32:35] offset:14080
    v_and_b32 v39, 0xffff0000, v38
    v_lshlrev_b32 v38, 16, v38
    v_and_b32 v37, 0xffff0000, v36
    v_lshlrev_b32 v36, 16, v36
    ds_write_b128 v1, v[36:39] offset:15104
    v_and_b32 v43, 0xffff0000, v42
    v_lshlrev_b32 v42, 16, v42
    v_and_b32 v41, 0xffff0000, v40
    v_lshlrev_b32 v40, 16, v40
    ds_write_b128 v1, v[40:43] offset:16128
    v_and_b32 v47, 0xffff0000, v46
    v_lshlrev_b32 v46, 16, v46
    v_and_b32 v45, 0xffff0000, v44
    v_lshlrev_b32 v44, 16, v44
    ds_write_b128 v1, v[44:47] offset:17152
    v_and_b32 v51, 0xffff0000, v50
    v_lshlrev_b32 v50, 16, v50
    v_and_b32 v49, 0xffff0000, v48
    v_lshlrev_b32 v48, 16, v48
    ds_write_b128 v1, v[48:51] offset:18176
    v_mov_b32 v12, 1
    s_mov_b64 exec, 1
    ds_add_u32 v23, v12 offset:24
    s_mov_b64 exec, -1
L_nomf:
    s_cmp_lg_u32 s3, 3
    s_cbranch_scc1 L_nofl
    s_mov_b32 s60, 300000
Lspin_94:
    ds_read_b32 v14, v23 offset:8
    s_waitcnt lgkmcnt(0)
    v_readfirstlane_b32 s9, v14
    s_nop 0
    s_cmp_ge_u32 s9, 8
    s_cbranch_scc1 Lsdone_95
    s_sub_u32 s60, s60, 1
    s_cbranch_scc1 Lsdone_95
    s_sleep 2
    s_branch Lspin_94
Lsdone_95:
    v_add_u32 v15, 229376, v1
    s_mov_b32 exec_hi, 0x3fffff
    s_mov_b32 s60, 30000
Lpoll_96:
    global_load_dwordx4 v[24:27], v15, s[42:43] sc1
    s_waitcnt vmcnt(0)
    v_max3_u32 v13, v24, v25, v26
    v_min3_u32 v14, v24, v25, v26
    v_max_u32 v13, v13, v27
    v_min_u32 v14, v14, v27
    v_xor_b32 v13, s58, v13
    v_xor_b32 v14, s58, v14
    v_or_b32 v13, v13, v14
    v_cmp_ne_u32 vcc, 0, v13
    s_cbranch_vccz Lpdone_97
    s_sub_u32 s60, s60, 1
    s_cbranch_scc1 Lpdone_97
    s_sleep 16
    s_branch Lpoll_96
Lpdone_97:
    v_mov_b32 v12, 1
    s_mov_b64 exec, 1
    ds_add_u32 v23, v12 offset:24
    s_mov_b64 exec, -1
L_nofl:
    s_mov_b32 s60, 300000
Lspin_98:
    ds_read_b32 v14, v23 offset:8
    s_waitcnt lgkmcnt(0)
    v_readfirstlane_b32 s9, v14
    s_nop 0
    s_cmp_ge_u32 s9, 8
    s_cbranch_scc1 Lsdone_99
    s_sub_u32 s60, s60, 1
    s_cbranch_scc1 Lsdone_99
    s_sleep 2
    s_branch Lspin_98
Lsdone_99:
    s_cmp_eq_u32 s3, 3
    s_cbranch_scc1 L_f_nodown
    global_load_dwordx4 v[156:159], v[10:11], off nt
    v_lshl_add_u64 v[10:11], v[10:11], 0, s[50:51]
    global_load_dwordx4 v[160:163], v[10:11], off nt
    v_lshl_add_u64 v[10:11], v[10:11], 0, s[50:51]
    global_load_dwordx4 v[164:167], v[10:11], off nt
    global_load_dwordx4 v[48:51], v8, s[32:33] offset:0 nt
    global_load_dwordx4 v[52:55], v8, s[32:33] offset:1152 nt
    global_load_dwordx4 v[56:59], v8, s[32:33] offset:2304 nt
    global_load_dwordx4 v[60:63], v8, s[32:33] offset:3456 nt
    global_load_dwordx4 v[64:67], v8, s[32:33] offset:128 nt
    global_load_dwordx4 v[68:71], v8, s[32:33] offset:1280 nt
    global_load_dwordx4 v[72:75], v8, s[32:33] offset:2432 nt
    global_load_dwordx4 v[76:79], v8, s[32:33] offset:3584 nt
    global_load_dwordx4 v[80:83], v8, s[32:33] offset:256 nt
    global_load_dwordx4 v[84:87], v8, s[32:33] offset:1408 nt
    global_load_dwordx4 v[88:91], v8, s[32:33] offset:2560 nt
    global_load_dwordx4 v[92:95], v8, s[32:33] offset:3712 nt
L_f_nodown:
    s_mov_b32 s60, 300000
Lspin_100:
    ds_read_b32 v14, v23 offset:24
    s_waitcnt lgkmcnt(0)
    v_readfirstlane_b32 s9, v14
    s_nop 0
    s_cmp_ge_u32 s9, 2
    s_cbranch_scc1 Lsdone_101
    s_sub_u32 s60, s60, 1
    s_cbranch_scc1 Lsdone_101
    s_sleep 2
    s_branch Lspin_100
Lsdone_101:
L_f_up:
    v_and_b32 v14, 1, v0
    v_lshlrev_b32 v14, 4, v14
    v_mov_b32 v15, 0xffff
    v_lshlrev_b32 v15, v14, v15
    v_and_b32 v14, 7, v0
    v_lshrrev_b32 v14, 1, v14
    v_cmp_eq_u32 vcc, 0, v14
    s_nop 1
    v_cndmask_b32 v16, 0, v15, vcc
    v_cmp_eq_u32 vcc, 1, v14
    s_nop 1
    v_cndmask_b32 v17, 0, v15, vcc
    v_cmp_eq_u32 vcc, 2, v14
    s_nop 1
    v_cndmask_b32 v18, 0, v15, vcc
    v_cmp_eq_u32 vcc, 3, v14
    s_nop 1
    v_cndmask_b32 v19, 0, v15, vcc
    s_mul_i32 s9, s3, 576
    v_lshl_add_u32 v12, v0, 2, s9
    v_lshlrev_b32 v13, 2, v0
    v_add_u32 v33, 14336, v12
    s_mul_i32 s9, s3, 768
    s_add_u32 s9, s9, 23552
    v_add_u32 v14, s9, v13
    v_lshrrev_b32 v15, 3, v0
    v_mul_u32_u24 v15, 72, v15
    v_add_u32 v15, s9, v15
    s_cmp_lg_u32 s3, 3
    s_cbranch_scc1 L_f_b5
    s_mov_b32 s11, 8
    s_branch L_hop2
L_s3pre:
    s_lshl_b32 s9, s10, 4
    s_add_u32 s11, s9, 11520
    v_mov_b32 v52, s11
    global_load_dwordx4 v[48:51], v52, s[42:43] sc1
L_f_b5:
    s_barrier
    ds_read2st64_b32 v[24:25], v13 offset0:83 offset1:84
    ds_read2st64_b32 v[26:27], v13 offset0:85 offset1:86
    ds_read2st64_b32 v[28:29], v13 offset0:87 offset1:88
    ds_read2st64_b32 v[30:31], v13 offset0:89 offset1:90
    ds_read_b32 v32, v13 offset:23296
    ds_read2st64_b32 v[44:45], v12 offset0:83 offset1:84
    ds_read_b32 v46, v12 offset:21760
    ds_read2st64_b32 v[36:37], v33 offset0:0 offset1:1
    ds_read_b32 v38, v33 offset:512
    ds_read2st64_b32 v[40:41], v33 offset0:9 offset1:10
    ds_read_b32 v42, v33 offset:2816
    s_waitcnt lgkmcnt(6)
    v_add_f32 v10, v24, v25
    v_add_f32 v11, v26, v27
    v_add_f32 v4, v28, v29
    v_add_f32 v5, v30, v31
    v_add_f32 v10, v10, v11
    v_add_f32 v4, v4, v5
    v_add_f32 v10, v10, v32
    v_add_f32 v10, v10, v4
    s_nop 1
    v_add_f32_dpp v10, v10, v10 row_ror:8 row_mask:0xf bank_mask:0xf
    s_nop 1
    v_add_f32_dpp v10, v10, v10 row_ror:4 row_mask:0xf bank_mask:0xf
    s_nop 1
    v_add_f32_dpp v10, v10, v10 row_ror:2 row_mask:0xf bank_mask:0xf
    s_nop 1
    v_add_f32_dpp v10, v10, v10 row_ror:1 row_mask:0xf bank_mask:0xf
    v_mov_b32 v11, v10
    s_nop 1
    v_permlane16_swap_b32 v10, v11
    v_add_f32 v10, v10, v11
    v_mov_b32 v11, v10
    s_nop 1
    v_permlane32_swap_b32 v10, v11
    v_add_f32 v10, v10, v11
    v_mul_f32 v10, 0x3ae38e39, v10
    s_waitcnt lgkmcnt(0)
    v_add_f32 v40, 1.0, v40
    v_add_f32 v41, 1.0, v41
    v_add_f32 v42, 1.0, v42
    v_cvt_pk_bf16_f32 v40, v40, v40
    v_and_b32 v40, 0xffff0000, v40
    v_cvt_pk_bf16_f32 v41, v41, v41
    v_and_b32 v41, 0xffff0000, v41
    v_cvt_pk_bf16_f32 v42, v42, v42
    v_and_b32 v42, 0xffff0000, v42
    v_sub_f32 v24, v24, v10
    v_sub_f32 v25, v25, v10
    v_sub_f32 v26, v26, v10
    v_sub_f32 v27, v27, v10
    v_sub_f32 v28, v28, v10
    v_sub_f32 v29, v29, v10
    v_sub_f32 v30, v30, v10
    v_sub_f32 v31, v31, v10
    v_sub_f32 v32, v32, v10
    v_mul_f32 v11, v24, v24
    v_mul_f32 v4, v25, v25
    v_fmac_f32 v11, v26, v26
    v_fmac_f32 v4, v27, v27
    v_fmac_f32 v11, v28, v28
    v_fmac_f32 v4, v29, v29
    v_fmac_f32 v11, v30, v30
    v_fmac_f32 v4, v31, v31
    v_fmac_f32 v11, v32, v32
    v_add_f32 v11, v11, v4
    s_nop 1
    v_add_f32_dpp v11, v11, v11 row_ror:8 row_mask:0xf bank_mask:0xf
    s_nop 1
    v_add_f32_dpp v11, v11, v11 row_ror:4 row_mask:0xf bank_mask:0xf
    s_nop 1
    v_add_f32_dpp v11, v11, v11 row_ror:2 row_mask:0xf bank_mask:0xf
    s_nop 1
    v_add_f32_dpp v11, v11, v11 row_ror:1 row_mask:0xf bank_mask:0xf
    v_mov_b32 v4, v11
    s_nop 1
    v_permlane16_swap_b32 v11, v4
    v_add_f32 v11, v11, v4
    v_mov_b32 v4, v11
    s_nop 1
    v_permlane32_swap_b32 v11, v4
    v_add_f32 v11, v11, v4
    v_mul_f32 v11, 0x3ae38e39, v11
    v_cvt_pk_bf16_f32 v11, v11, v11
    v_and_b32 v11, 0xffff0000, v11
    v_add_f32 v11, 0x3727c5ac, v11
    v_cvt_pk_bf16_f32 v11, v11, v11
    v_and_b32 v11, 0xffff0000, v11
    v_sqrt_f32 v11, v11
    s_nop 0
    v_cvt_pk_bf16_f32 v11, v11, v11
    v_and_b32 v11, 0xffff0000, v11
    v_rcp_f32 v11, v11
    v_cvt_pk_bf16_f32 v10, v10, v10
    v_and_b32 v10, 0xffff0000, v10
    s_waitcnt lgkmcnt(0)
    v_sub_f32 v44, v44, v10
    v_sub_f32 v45, v45, v10
    v_sub_f32 v46, v46, v10
    v_cvt_pk_bf16_f32 v44, v44, v44
    v_and_b32 v44, 0xffff0000, v44
    v_cvt_pk_bf16_f32 v45, v45, v45
    v_and_b32 v45, 0xffff0000, v45
    v_cvt_pk_bf16_f32 v46, v46, v46
    v_and_b32 v46, 0xffff0000, v46
    v_mul_f32 v44, v44, v11
    v_mul_f32 v45, v45, v11
    v_mul_f32 v46, v46, v11
    v_cvt_pk_bf16_f32 v44, v44, v44
    v_and_b32 v44, 0xffff0000, v44
    v_cvt_pk_bf16_f32 v45, v45, v45
    v_and_b32 v45, 0xffff0000, v45
    v_cvt_pk_bf16_f32 v46, v46, v46
    v_and_b32 v46, 0xffff0000, v46
    v_mul_f32 v44, v44, v40
    v_mul_f32 v45, v45, v41
    v_mul_f32 v46, v46, v42
    v_cvt_pk_bf16_f32 v44, v44, v44
    v_and_b32 v44, 0xffff0000, v44
    v_cvt_pk_bf16_f32 v45, v45, v45
    v_and_b32 v45, 0xffff0000, v45
    v_cvt_pk_bf16_f32 v46, v46, v46
    v_and_b32 v46, 0xffff0000, v46
    v_add_f32 v44, v44, v36
    v_add_f32 v45, v45, v37
    v_add_f32 v46, v46, v38
    v_cvt_pk_bf16_f32 v44, v44, v44
    v_cvt_pk_bf16_f32 v45, v45, v45
    v_cvt_pk_bf16_f32 v46, v46, v46
    ds_write2st64_b32 v14, v44, v45 offset0:0 offset1:1
    ds_write_b32 v14, v46 offset:512
    s_waitcnt lgkmcnt(0)
    ds_read_b64 v[24:25], v15 offset:0
    ds_read_b64 v[26:27], v15 offset:8
    ds_read_b64 v[28:29], v15 offset:16
    ds_read_b64 v[30:31], v15 offset:24
    ds_read_b64 v[32:33], v15 offset:32
    ds_read_b64 v[34:35], v15 offset:40
    ds_read_b64 v[36:37], v15 offset:48
    ds_read_b64 v[38:39], v15 offset:56
    ds_read_b64 v[40:41], v15 offset:64
    v_lshrrev_b32 v12, 5, v0
    v_lshlrev_b32 v12, 8, v12
    v_and_b32 v13, 7, v0
    v_lshl_add_u32 v12, v13, 5, v12
    v_bfe_u32 v13, v0, 4, 1
    v_lshl_add_u32 v12, v13, 4, v12
    s_lshl_b32 s9, s3, 9
    v_add_u32 v12, s9, v12
    s_mov_b32 s48, 0x00ff00ff
    s_mov_b32 s49, 0xff00ff00
    s_waitcnt lgkmcnt(0) vmcnt(12)
    s_cmp_lg_u32 s3, 3
    s_cbranch_scc1 L_f_w1
    s_waitcnt vmcnt(1)
L_f_w1:
    v_and_b32 v4, v24, v16
    v_and_b32 v5, v24, v17
    v_and_b32 v6, v24, v18
    v_and_b32 v7, v24, v19
    v_and_b32 v8, v25, v16
    v_and_b32 v9, v25, v17
    v_and_b32 v10, v25, v18
    v_and_b32 v11, v25, v19
    v_mfma_f32_16x16x32_bf16 v[44:47], v[4:7], v[96:99], 0
    v_and_b32 v4, v26, v16
    v_and_b32 v5, v26, v17
    v_and_b32 v6, v26, v18
    v_and_b32 v7, v26, v19
    v_mfma_f32_16x16x32_bf16 v[44:47], v[8:11], v[100:103], v[44:47]
    v_and_b32 v8, v27, v16
    v_and_b32 v9, v27, v17
    v_and_b32 v10, v27, v18
    v_and_b32 v11, v27, v19
    v_mfma_f32_16x16x32_bf16 v[44:47], v[4:7], v[104:107], v[44:47]
    v_and_b32 v4, v28, v16
    v_and_b32 v5, v28, v17
    v_and_b32 v6, v28, v18
    v_and_b32 v7, v28, v19
    v_mfma_f32_16x16x32_bf16 v[44:47], v[8:11], v[108:111], v[44:47]
    v_and_b32 v8, v29, v16
    v_and_b32 v9, v29, v17
    v_and_b32 v10, v29, v18
    v_and_b32 v11, v29, v19
    v_mfma_f32_16x16x32_bf16 v[44:47], v[4:7], v[112:115], v[44:47]
    v_and_b32 v4, v30, v16
    v_and_b32 v5, v30, v17
    v_and_b32 v6, v30, v18
    v_and_b32 v7, v30, v19
    v_mfma_f32_16x16x32_bf16 v[44:47], v[8:11], v[116:119], v[44:47]
    v_and_b32 v8, v31, v16
    v_and_b32 v9, v31, v17
    v_and_b32 v10, v31, v18
    v_and_b32 v11, v31, v19
    v_mfma_f32_16x16x32_bf16 v[44:47], v[4:7], v[120:123], v[44:47]
    v_and_b32 v4, v32, v16
    v_and_b32 v5, v32, v17
    v_and_b32 v6, v32, v18
    v_and_b32 v7, v32, v19
    v_mfma_f32_16x16x32_bf16 v[44:47], v[8:11], v[124:127], v[44:47]
    v_and_b32 v8, v33, v16
    v_and_b32 v9, v33, v17
    v_and_b32 v10, v33, v18
    v_and_b32 v11, v33, v19
    v_mfma_f32_16x16x32_bf16 v[44:47], v[4:7], v[128:131], v[44:47]
    v_and_b32 v4, v34, v16
    v_and_b32 v5, v34, v17
    v_and_b32 v6, v34, v18
    v_and_b32 v7, v34, v19
    v_mfma_f32_16x16x32_bf16 v[44:47], v[8:11], v[132:135], v[44:47]
    v_and_b32 v8, v35, v16
    v_and_b32 v9, v35, v17
    v_and_b32 v10, v35, v18
    v_and_b32 v11, v35, v19
    v_mfma_f32_16x16x32_bf16 v[44:47], v[4:7], v[136:139], v[44:47]
    v_and_b32 v4, v36, v16
    v_and_b32 v5, v36, v17
    v_and_b32 v6, v36, v18
    v_and_b32 v7, v36, v19
    v_mfma_f32_16x16x32_bf16 v[44:47], v[8:11], v[140:143], v[44:47]
    v_and_b32 v8, v37, v16
    v_and_b32 v9, v37, v17
    v_and_b32 v10, v37, v18
    v_and_b32 v11, v37, v19
    v_mfma_f32_16x16x32_bf16 v[44:47], v[4:7], v[144:147], v[44:47]
    v_and_b32 v4, v38, v16
    v_and_b32 v5, v38, v17
    v_and_b32 v6, v38, v18
    v_and_b32 v7, v38, v19
    v_mfma_f32_16x16x32_bf16 v[44:47], v[8:11], v[148:151], v[44:47]
    v_and_b32 v8, v39, v16
    v_and_b32 v9, v39, v17
    v_and_b32 v10, v39, v18
    v_and_b32 v11, v39, v19
    v_mfma_f32_16x16x32_bf16 v[44:47], v[4:7], v[152:155], v[44:47]
    v_and_b32 v4, v40, v16
    v_and_b32 v5, v40, v17
    v_and_b32 v6, v40, v18
    v_and_b32 v7, v40, v19
    v_mfma_f32_16x16x32_bf16 v[44:47], v[8:11], v[156:159], v[44:47]
    v_and_b32 v8, v41, v16
    v_and_b32 v9, v41, v17
    v_and_b32 v10, v41, v18
    v_and_b32 v11, v41, v19
    v_mfma_f32_16x16x32_bf16 v[44:47], v[4:7], v[160:163], v[44:47]
    s_nop 0
    v_mfma_f32_16x16x32_bf16 v[44:47], v[8:11], v[164:167], v[44:47]
    s_mov_b64 exec, s[48:49]
    s_nop 6
    ds_write_b128 v12, v[44:47] offset:26624
    s_mov_b64 exec, -1
    v_lshlrev_b32 v13, 2, v0
    s_waitcnt lgkmcnt(0)
    s_barrier
    s_cmp_eq_u32 s3, 3
    s_cbranch_scc1 L_final
    ds_read2st64_b32 v[24:25], v13 offset0:104 offset1:105
    ds_read2st64_b32 v[26:27], v13 offset0:106 offset1:107
    ds_read2st64_b32 v[28:29], v13 offset0:108 offset1:109
    ds_read2st64_b32 v[30:31], v13 offset0:110 offset1:111
    v_lshrrev_b32 v15, 3, v0
    v_lshlrev_b32 v15, 4, v15
    s_mul_i32 s9, s3, 768
    v_add_u32 v15, s9, v15
    s_waitcnt lgkmcnt(0)
    v_add_f32 v24, v24, v25
    v_add_f32 v26, v26, v27
    v_add_f32 v28, v28, v29
    v_add_f32 v30, v30, v31
    v_add_f32 v24, v24, v26
    v_add_f32 v28, v28, v30
    v_add_f32 v24, v24, v28
    v_cvt_pk_bf16_f32 v24, v24, v24
    v_and_b32 v24, 0xffff0000, v24
    v_mov_b32 v25, v24
    s_nop 1
    v_permlane32_swap_b32 v24, v25
    v_mul_f32 v26, 0xbfb8aa3b, v24
    v_exp_f32 v26, v26
    s_nop 0
    v_add_f32 v26, 1.0, v26
    v_rcp_f32 v26, v26
    s_nop 0
    v_mul_f32 v24, v24, v26
    v_cvt_pk_bf16_f32 v24, v24, v24
    v_and_b32 v24, 0xffff0000, v24
    v_mul_f32 v24, v24, v25
    v_cvt_pk_bf16_f32 v24, v24, v24
    ds_write_b32 v14, v24
    s_waitcnt lgkmcnt(0)
    ds_read_b128 v[24:27], v15 offset:23552
    v_lshrrev_b32 v12, 5, v0
    v_lshlrev_b32 v12, 8, v12
    v_and_b32 v13, 7, v0
    v_lshl_add_u32 v12, v13, 5, v12
    v_bfe_u32 v13, v0, 4, 1
    v_lshl_add_u32 v12, v13, 4, v12
    s_mul_i32 s9, s10, 2304
    s_mul_i32 s11, s3, 768
    s_add_u32 s9, s9, s11
    s_add_u32 s9, s9, 458752
    v_add_u32 v12, s9, v12
    s_mov_b32 s48, 0x00ff00ff
    s_mov_b32 s49, 0x00ff00ff
    s_waitcnt lgkmcnt(0) vmcnt(0)
    v_and_b32 v96, v24, v16
    v_and_b32 v97, v24, v17
    v_and_b32 v98, v24, v18
    v_and_b32 v99, v24, v19
    v_and_b32 v100, v25, v16
    v_and_b32 v101, v25, v17
    v_and_b32 v102, v25, v18
    v_and_b32 v103, v25, v19
    v_and_b32 v104, v26, v16
    v_and_b32 v105, v26, v17
    v_and_b32 v106, v26, v18
    v_and_b32 v107, v26, v19
    v_and_b32 v108, v27, v16
    v_and_b32 v109, v27, v17
    v_and_b32 v110, v27, v18
    v_and_b32 v111, v27, v19
    v_mfma_f32_16x16x32_bf16 v[28:31], v[96:99], v[48:51], 0
    v_mfma_f32_16x16x32_bf16 v[32:35], v[96:99], v[64:67], 0
    v_mfma_f32_16x16x32_bf16 v[36:39], v[96:99], v[80:83], 0
    v_mfma_f32_16x16x32_bf16 v[28:31], v[100:103], v[52:55], v[28:31]
    v_mfma_f32_16x16x32_bf16 v[32:35], v[100:103], v[68:71], v[32:35]
    v_mfma_f32_16x16x32_bf16 v[36:39], v[100:103], v[84:87], v[36:39]
    v_mfma_f32_16x16x32_bf16 v[28:31], v[104:107], v[56:59], v[28:31]
    v_mfma_f32_16x16x32_bf16 v[32:35], v[104:107], v[72:75], v[32:35]
    v_mfma_f32_16x16x32_bf16 v[36:39], v[104:107], v[88:91], v[36:39]
    v_mfma_f32_16x16x32_bf16 v[28:31], v[108:111], v[60:63], v[28:31]
    v_mfma_f32_16x16x32_bf16 v[32:35], v[108:111], v[76:79], v[32:35]
    v_mfma_f32_16x16x32_bf16 v[36:39], v[108:111], v[92:95], v[36:39]
    s_nop 6
    v_permlane32_swap_b32 v28, v32
    v_permlane32_swap_b32 v29, v33
    v_permlane32_swap_b32 v30, v34
    v_permlane32_swap_b32 v31, v35
    v_mov_b32 v40, v36
    v_mov_b32 v41, v37
    v_mov_b32 v42, v38
    v_mov_b32 v43, v39
    v_add_f32_dpp v28, v32, v28 row_ror:8 row_mask:0xf bank_mask:0xf
    v_add_f32_dpp v29, v33, v29 row_ror:8 row_mask:0xf bank_mask:0xf
    v_add_f32_dpp v30, v34, v30 row_ror:8 row_mask:0xf bank_mask:0xf
    v_add_f32_dpp v31, v35, v31 row_ror:8 row_mask:0xf bank_mask:0xf
    v_permlane32_swap_b32 v36, v40
    v_permlane32_swap_b32 v37, v41
    v_permlane32_swap_b32 v38, v42
    v_permlane32_swap_b32 v39, v43
    v_min_u32 v28, -2, v28
    v_min_u32 v29, -2, v29
    v_min_u32 v30, -2, v30
    v_min_u32 v31, -2, v31
    s_mov_b64 exec, s[48:49]
    global_store_dwordx4 v12, v[28:31], s[42:43] sc1
    s_mov_b64 exec, -1
    v_add_f32_dpp v36, v40, v36 row_ror:8 row_mask:0xf bank_mask:0xf
    v_add_f32_dpp v37, v41, v37 row_ror:8 row_mask:0xf bank_mask:0xf
    v_add_f32_dpp v38, v42, v38 row_ror:8 row_mask:0xf bank_mask:0xf
    v_add_f32_dpp v39, v43, v39 row_ror:8 row_mask:0xf bank_mask:0xf
    v_min_u32 v36, -2, v36
    v_min_u32 v37, -2, v37
    v_min_u32 v38, -2, v38
    v_min_u32 v39, -2, v39
    s_mov_b64 exec, 0x00ff00ff
    global_store_dwordx4 v12, v[36:39], s[42:43] offset:512 sc1
    s_mov_b64 exec, -1
    s_endpgm
L_final:
    v_mul_u32_u24 v12, 2304, v0
    s_lshl_b32 s9, s10, 4
    s_add_u32 s11, s9, 458752
    v_add_u32 v12, s11, v12
    v_add_u32 v13, 147456, v12
    v_add_u32 v14, 294912, v12
    v_lshrrev_b32 v3, 4, v0
    v_and_b32 v7, 1, v3
    v_lshlrev_b32 v7, 1, v7
    v_lshrrev_b32 v3, 1, v3
    v_add_u32 v7, v7, v3
    v_lshl_add_u32 v8, v7, 2, s9
    ds_read_b32 v10, v8 offset:21248
    v_lshrrev_b32 v8, 1, v8
    s_add_u32 s11, s9, 11520
    v_mov_b32 v4, s11
    s_waitcnt vmcnt(0)
    v_mov_b32 v24, v48
    v_mov_b32 v25, v49
    v_mov_b32 v26, v50
    v_mov_b32 v27, v51
    v_xor_b32 v5, s58, v25
    v_xor_b32 v6, s58, v27
    v_or_b32 v5, v5, v6
    v_cmp_ne_u32 vcc, 0, v5
    s_cbranch_vccz L_gbok
    s_mov_b32 s60, 30000
Lpoll_102:
    global_load_dwordx4 v[24:27], v4, s[42:43] sc1
    s_waitcnt vmcnt(0)
    v_xor_b32 v5, s58, v25
    v_xor_b32 v6, s58, v27
    v_or_b32 v5, v5, v6
    v_cmp_ne_u32 vcc, 0, v5
    s_cbranch_vccz Lpdone_103
    s_sub_u32 s60, s60, 1
    s_cbranch_scc1 Lpdone_103
    s_sleep 1
    s_branch Lpoll_102
Lpdone_103:
L_gbok:
    v_cmp_le_u32 vcc, 2, v7
    s_nop 1
    v_cndmask_b32 v9, v24, v26, vcc
    v_and_b32 v7, 1, v7
    v_xor_b32 v7, 1, v7
    v_lshlrev_b32 v7, 4, v7
    v_lshlrev_b32 v9, v7, v9
    v_and_b32 v9, 0xffff0000, v9
    v_mov_b32 v32, 0
    v_mov_b32 v33, 0
    v_mov_b32 v34, 0
    v_mov_b32 v35, 0
    s_waitcnt vmcnt(0)
    v_mov_b32 v24, -1
    v_mov_b32 v25, -1
    v_mov_b32 v26, -1
    v_mov_b32 v27, -1
    v_mov_b32 v28, -1
    v_mov_b32 v29, -1
    v_mov_b32 v30, -1
    v_mov_b32 v31, -1
    v_mov_b32 v32, 0
    v_mov_b32 v33, 0
    v_mov_b32 v34, 0
    v_mov_b32 v35, 0
    s_mov_b64 exec, 65535
    v_mov_b32 v32, -1
    v_mov_b32 v33, -1
    v_mov_b32 v34, -1
    v_mov_b32 v35, -1
    s_mov_b64 exec, -1
    global_load_dwordx4 v[60:63], v12, s[42:43] sc1
    global_load_dwordx4 v[64:67], v13, s[42:43] sc1
    s_mov_b64 exec, 65535
    global_load_dwordx4 v[68:71], v14, s[42:43] sc1
    s_mov_b64 exec, -1
    s_mov_b32 s60, s59
Lpp_104:
    s_waitcnt vmcnt(0)
    v_min_u32 v24, v24, v60
    v_min_u32 v25, v25, v61
    v_min_u32 v26, v26, v62
    v_min_u32 v27, v27, v63
    v_min_u32 v28, v28, v64
    v_min_u32 v29, v29, v65
    v_min_u32 v30, v30, v66
    v_min_u32 v31, v31, v67
    v_min_u32 v32, v32, v68
    v_min_u32 v33, v33, v69
    v_min_u32 v34, v34, v70
    v_min_u32 v35, v35, v71
    v_max3_u32 v60, v24, v25, v26
    v_max_u32 v60, v60, v27
    v_max3_u32 v64, v28, v29, v30
    v_max_u32 v64, v64, v31
    v_max3_u32 v68, v32, v33, v34
    v_max_u32 v68, v68, v35
    v_cmp_eq_u32 s[88:89], -1, v60
    v_cmp_eq_u32 s[92:93], -1, v64
    v_cmp_eq_u32 s[94:95], -1, v68
    v_mov_b32 v60, -1
    v_mov_b32 v64, -1
    v_mov_b32 v68, -1
    s_bcnt1_i32_b64 s9, s[88:89]
    s_bcnt1_i32_b64 s61, s[92:93]
    s_add_u32 s9, s9, s61
    s_bcnt1_i32_b64 s61, s[94:95]
    s_add_u32 s9, s9, s61
    s_cmp_eq_u32 s9, 0
    s_cbranch_scc1 Lppd_105
    s_cmp_eq_u64 s[88:89], 0
    s_cselect_b64 exec, 1, s[88:89]
    global_load_dwordx4 v[60:63], v12, s[42:43] sc1
    s_cmp_eq_u64 s[92:93], 0
    s_cselect_b64 exec, 1, s[92:93]
    global_load_dwordx4 v[64:67], v13, s[42:43] sc1
    s_cmp_eq_u64 s[94:95], 0
    s_cselect_b64 exec, 1, s[94:95]
    global_load_dwordx4 v[68:71], v14, s[42:43] sc1
    s_mov_b64 exec, -1
    s_sub_u32 s60, s60, 1
    s_cbranch_scc0 Lpp_104
Lppd_105:
    v_add_f32 v24, v24, v28
    v_add_f32 v25, v25, v29
    v_add_f32 v26, v26, v30
    v_add_f32 v27, v27, v31
    v_add_f32 v24, v24, v32
    v_add_f32 v25, v25, v33
    v_add_f32 v26, v26, v34
    v_add_f32 v27, v27, v35
    v_permlane32_swap_b32 v24, v25
    s_nop 0
    v_permlane32_swap_b32 v26, v27
    v_add_f32 v24, v24, v25
    v_add_f32 v26, v26, v27
    s_nop 1
    v_permlane16_swap_b32 v24, v26
    v_add_f32 v24, v24, v26
    s_nop 1
    v_add_f32_dpp v24, v24, v24 row_ror:8 row_mask:0xf bank_mask:0xf
    s_nop 1
    v_add_f32_dpp v24, v24, v24 row_ror:4 row_mask:0xf bank_mask:0xf
    s_nop 1
    v_add_f32_dpp v24, v24, v24 row_ror:2 row_mask:0xf bank_mask:0xf
    s_nop 1
    v_add_f32_dpp v24, v24, v24 row_ror:1 row_mask:0xf bank_mask:0xf
    v_cvt_pk_bf16_f32 v24, v24, v24
    v_and_b32 v24, 0xffff0000, v24
    s_waitcnt lgkmcnt(0)
    v_mul_f32 v24, v24, v9
    v_cvt_pk_bf16_f32 v24, v24, v24
    v_and_b32 v24, 0xffff0000, v24
    v_add_f32 v24, v24, v10
    v_cvt_pk_bf16_f32 v24, v24, v24
    s_mov_b32 s48, 0x00010001
    s_mov_b32 s49, 0x00010001
    s_mov_b64 exec, s[48:49]
    global_store_short v8, v24, s[38:39]
    s_mov_b64 exec, -1
    s_cmp_lg_u32 s10, 0
    s_cbranch_scc1 L_noep
    s_mov_b64 exec, 1
    v_mov_b32 v12, 245760
    v_mov_b32 v13, s58
    global_store_dword v12, v13, s[42:43] sc1
    s_mov_b64 exec, -1
L_noep:
    s_endpgm
L_w:
    s_lshl_b32 s11, s4, 2
    s_add_u32 s11, s11, s3
    s_sub_u32 s12, s5, 18
    v_lshrrev_b32 v8, 3, v0
    v_lshlrev_b32 v8, 4, v8
    s_lshl_b32 s9, s11, 7
    v_add_u32 v8, s9, v8
    v_mul_u32_u24 v8, 1152, v8
    v_and_b32 v9, 7, v0
    v_lshl_add_u32 v8, v9, 4, v8
    s_lshl_b32 s9, s12, 7
    v_add_u32 v8, s9, v8
    s_mov_b32 s60, 300000
Lspin_106:
    ds_read_b32 v14, v23 offset:0
    s_waitcnt lgkmcnt(0)
    v_readfirstlane_b32 s9, v14
    s_nop 0
    s_cmp_ge_u32 s9, 8
    s_cbranch_scc1 Lsdone_107
    s_sub_u32 s60, s60, 1
    s_cbranch_scc1 Lsdone_107
    s_sleep 2
    s_branch Lspin_106
Lsdone_107:
    global_load_dwordx4 v[96:99], v8, s[24:25] offset:0 nt
    global_load_dwordx4 v[100:103], v8, s[24:25] offset:1152 nt
    global_load_dwordx4 v[104:107], v8, s[24:25] offset:2304 nt
    s_waitcnt vmcnt(2)
    global_load_dwordx4 v[108:111], v8, s[24:25] offset:3456 nt
    v_add_u32 v8, 4608, v8
    s_waitcnt vmcnt(2)
    global_load_dwordx4 v[112:115], v8, s[24:25] offset:0 nt
    s_waitcnt vmcnt(2)
    global_load_dwordx4 v[116:119], v8, s[24:25] offset:1152 nt
    s_waitcnt vmcnt(2)
    global_load_dwordx4 v[120:123], v8, s[24:25] offset:2304 nt
    s_waitcnt vmcnt(2)
    global_load_dwordx4 v[124:127], v8, s[24:25] offset:3456 nt
    v_add_u32 v8, 4608, v8
    s_waitcnt vmcnt(2)
    global_load_dwordx4 v[128:131], v8, s[24:25] offset:0 nt
    s_waitcnt vmcnt(2)
    global_load_dwordx4 v[132:135], v8, s[24:25] offset:1152 nt
    s_waitcnt vmcnt(2)
    global_load_dwordx4 v[136:139], v8, s[24:25] offset:2304 nt
    s_waitcnt vmcnt(2)
    global_load_dwordx4 v[140:143], v8, s[24:25] offset:3456 nt
    v_add_u32 v8, 4608, v8
    s_waitcnt vmcnt(2)
    global_load_dwordx4 v[144:147], v8, s[24:25] offset:0 nt
    s_waitcnt vmcnt(2)
    global_load_dwordx4 v[148:151], v8, s[24:25] offset:1152 nt
    s_waitcnt vmcnt(2)
    global_load_dwordx4 v[152:155], v8, s[24:25] offset:2304 nt
    s_waitcnt vmcnt(2)
    global_load_dwordx4 v[156:159], v8, s[24:25] offset:3456 nt
L_w_nold:
    s_lshl_b32 s9, s11, 13
    s_add_u32 s9, s9, 1314816
    v_add_u32 v12, s9, v1
    s_mul_i32 s9, s3, 768
    s_add_u32 s9, s9, 23552
    v_lshl_add_u32 v14, v0, 3, s9
    v_lshrrev_b32 v15, 3, v0
    v_lshlrev_b32 v15, 6, v15
    v_add_u32 v15, s9, v15
    v_lshrrev_b32 v56, 5, v0
    v_lshlrev_b32 v56, 8, v56
    v_and_b32 v13, 7, v0
    v_lshl_add_u32 v56, v13, 5, v56
    v_bfe_u32 v13, v0, 4, 1
    v_lshl_add_u32 v56, v13, 4, v56
    s_lshl_b32 s9, s3, 9
    v_add_u32 v56, s9, v56
    s_mul_i32 s9, s4, 2304
    s_lshl_b32 s12, s12, 8
    s_add_u32 s9, s9, s12
    s_add_u32 s9, s9, 393216
    v_add_u32 v57, s9, v1
    s_mov_b32 s48, 0x00ff00ff
    s_mov_b32 s49, 0xff00ff00
    s_mov_b32 s60, 300000
Lspin_108:
    ds_read_b32 v13, v23 offset:20
    s_waitcnt lgkmcnt(0)
    v_readfirstlane_b32 s9, v13
    s_nop 0
    s_cmp_ge_u32 s9, 1
    s_cbranch_scc1 Lsdone_109
    s_sub_u32 s60, s60, 1
    s_cbranch_scc1 Lsdone_109
    s_sleep 2
    s_branch Lspin_108
Lsdone_109:
    s_mov_b32 s60, 30000
    s_mov_b64 s[96:97], s[42:43]
    s_mov_b32 s92, 255
Lpoll_110:
    s_bitcmp1_b32 s92, 0
    s_cbranch_scc0 Ls_112
    global_load_dwordx4 v[24:27], v12, s[96:97] offset:-4096 sc1
Ls_112:
    s_bitcmp1_b32 s92, 1
    s_cbranch_scc0 Ls_113
    global_load_dwordx4 v[28:31], v12, s[96:97] offset:-3072 sc1
Ls_113:
    s_bitcmp1_b32 s92, 2
    s_cbranch_scc0 Ls_114
    global_load_dwordx4 v[32:35], v12, s[96:97] offset:-2048 sc1
Ls_114:
    s_bitcmp1_b32 s92, 3
    s_cbranch_scc0 Ls_115
    global_load_dwordx4 v[36:39], v12, s[96:97] offset:-1024 sc1
Ls_115:
    s_bitcmp1_b32 s92, 4
    s_cbranch_scc0 Ls_116
    global_load_dwordx4 v[40:43], v12, s[96:97] offset:0 sc1
Ls_116:
    s_bitcmp1_b32 s92, 5
    s_cbranch_scc0 Ls_117
    global_load_dwordx4 v[44:47], v12, s[96:97] offset:1024 sc1
Ls_117:
    s_bitcmp1_b32 s92, 6
    s_cbranch_scc0 Ls_118
    global_load_dwordx4 v[48:51], v12, s[96:97] offset:2048 sc1
Ls_118:
    s_bitcmp1_b32 s92, 7
    s_cbranch_scc0 Ls_119
    global_load_dwordx4 v[52:55], v12, s[96:97] offset:3072 sc1
Ls_119:
    s_waitcnt vmcnt(0)
    s_bitcmp1_b32 s92, 0
    s_cbranch_scc0 Lc_120
    v_xor_b32 v13, s58, v25
    v_xor_b32 v4, s58, v27
    v_or_b32 v13, v13, v4
    v_cmp_ne_u32 vcc, 0, v13
    s_cbranch_vccnz Lc_120
    s_bitset0_b32 s92, 0
Lc_120:
    s_bitcmp1_b32 s92, 1
    s_cbranch_scc0 Lc_121
    v_xor_b32 v13, s58, v29
    v_xor_b32 v4, s58, v31
    v_or_b32 v13, v13, v4
    v_cmp_ne_u32 vcc, 0, v13
    s_cbranch_vccnz Lc_121
    s_bitset0_b32 s92, 1
Lc_121:
    s_bitcmp1_b32 s92, 2
    s_cbranch_scc0 Lc_122
    v_xor_b32 v13, s58, v33
    v_xor_b32 v4, s58, v35
    v_or_b32 v13, v13, v4
    v_cmp_ne_u32 vcc, 0, v13
    s_cbranch_vccnz Lc_122
    s_bitset0_b32 s92, 2
Lc_122:
    s_bitcmp1_b32 s92, 3
    s_cbranch_scc0 Lc_123
    v_xor_b32 v13, s58, v37
    v_xor_b32 v4, s58, v39
    v_or_b32 v13, v13, v4
    v_cmp_ne_u32 vcc, 0, v13
    s_cbranch_vccnz Lc_123
    s_bitset0_b32 s92, 3
Lc_123:
    s_bitcmp1_b32 s92, 4
    s_cbranch_scc0 Lc_124
    v_xor_b32 v13, s58, v41
    v_xor_b32 v4, s58, v43
    v_or_b32 v13, v13, v4
    v_cmp_ne_u32 vcc, 0, v13
    s_cbranch_vccnz Lc_124
    s_bitset0_b32 s92, 4
Lc_124:
    s_bitcmp1_b32 s92, 5
    s_cbranch_scc0 Lc_125
    v_xor_b32 v13, s58, v45
    v_xor_b32 v4, s58, v47
    v_or_b32 v13, v13, v4
    v_cmp_ne_u32 vcc, 0, v13
    s_cbranch_vccnz Lc_125
    s_bitset0_b32 s92, 5
Lc_125:
    s_bitcmp1_b32 s92, 6
    s_cbranch_scc0 Lc_126
    v_xor_b32 v13, s58, v49
    v_xor_b32 v4, s58, v51
    v_or_b32 v13, v13, v4
    v_cmp_ne_u32 vcc, 0, v13
    s_cbranch_vccnz Lc_126
    s_bitset0_b32 s92, 6
Lc_126:
    s_bitcmp1_b32 s92, 7
    s_cbranch_scc0 Lc_127
    v_xor_b32 v13, s58, v53
    v_xor_b32 v4, s58, v55
    v_or_b32 v13, v13, v4
    v_cmp_ne_u32 vcc, 0, v13
    s_cbranch_vccnz Lc_127
    s_bitset0_b32 s92, 7
Lc_127:
    s_cmp_eq_u32 s92, 0
    s_cbranch_scc1 Lpdone_111
    s_sub_u32 s60, s60, 1
    s_cbranch_scc1 Lpdone_111
    s_and_b32 s9, s60, 15
    s_cselect_b64 s[96:97], s[42:43], s[98:99]
    s_sleep 1
    s_branch Lpoll_110
Lpdone_111:
    v_add_f32 v24, v24, v28
    v_add_f32 v26, v26, v30
    v_add_f32 v32, v32, v36
    v_add_f32 v34, v34, v38
    v_add_f32 v40, v40, v44
    v_add_f32 v42, v42, v46
    v_add_f32 v48, v48, v52
    v_add_f32 v50, v50, v54
    v_add_f32 v24, v24, v32
    v_add_f32 v26, v26, v34
    v_add_f32 v40, v40, v48
    v_add_f32 v42, v42, v50
    v_add_f32 v24, v24, v40
    v_add_f32 v26, v26, v42
    v_cvt_pk_bf16_f32 v24, v24, v24
    v_cvt_pk_bf16_f32 v25, v26, v26
    ds_write_b64 v14, v[24:25]
    s_waitcnt lgkmcnt(0)
    ds_read_b128 v[24:27], v15 offset:0
    ds_read_b128 v[28:31], v15 offset:16
    ds_read_b128 v[32:35], v15 offset:32
    ds_read_b128 v[36:39], v15 offset:48
    s_waitcnt lgkmcnt(0)
    v_and_b32 v4, v24, v16
    v_and_b32 v5, v24, v17
    v_and_b32 v6, v24, v18
    v_and_b32 v7, v24, v19
    v_and_b32 v48, v25, v16
    v_and_b32 v49, v25, v17
    v_and_b32 v50, v25, v18
    v_and_b32 v51, v25, v19
    v_mfma_f32_16x16x32_bf16 v[44:47], v[4:7], v[96:99], 0
    v_and_b32 v4, v26, v16
    v_and_b32 v5, v26, v17
    v_and_b32 v6, v26, v18
    v_and_b32 v7, v26, v19
    v_mfma_f32_16x16x32_bf16 v[44:47], v[48:51], v[100:103], v[44:47]
    v_and_b32 v48, v27, v16
    v_and_b32 v49, v27, v17
    v_and_b32 v50, v27, v18
    v_and_b32 v51, v27, v19
    v_mfma_f32_16x16x32_bf16 v[44:47], v[4:7], v[104:107], v[44:47]
    v_and_b32 v4, v28, v16
    v_and_b32 v5, v28, v17
    v_and_b32 v6, v28, v18
    v_and_b32 v7, v28, v19
    v_mfma_f32_16x16x32_bf16 v[44:47], v[48:51], v[108:111], v[44:47]
    v_and_b32 v48, v29, v16
    v_and_b32 v49, v29, v17
    v_and_b32 v50, v29, v18
    v_and_b32 v51, v29, v19
    v_mfma_f32_16x16x32_bf16 v[44:47], v[4:7], v[112:115], v[44:47]
    v_and_b32 v4, v30, v16
    v_and_b32 v5, v30, v17
    v_and_b32 v6, v30, v18
    v_and_b32 v7, v30, v19
    v_mfma_f32_16x16x32_bf16 v[44:47], v[48:51], v[116:119], v[44:47]
    v_and_b32 v48, v31, v16
    v_and_b32 v49, v31, v17
    v_and_b32 v50, v31, v18
    v_and_b32 v51, v31, v19
    v_mfma_f32_16x16x32_bf16 v[44:47], v[4:7], v[120:123], v[44:47]
    v_and_b32 v4, v32, v16
    v_and_b32 v5, v32, v17
    v_and_b32 v6, v32, v18
    v_and_b32 v7, v32, v19
    v_mfma_f32_16x16x32_bf16 v[44:47], v[48:51], v[124:127], v[44:47]
    v_and_b32 v48, v33, v16
    v_and_b32 v49, v33, v17
    v_and_b32 v50, v33, v18
    v_and_b32 v51, v33, v19
    v_mfma_f32_16x16x32_bf16 v[44:47], v[4:7], v[128:131], v[44:47]
    v_and_b32 v4, v34, v16
    v_and_b32 v5, v34, v17
    v_and_b32 v6, v34, v18
    v_and_b32 v7, v34, v19
    v_mfma_f32_16x16x32_bf16 v[44:47], v[48:51], v[132:135], v[44:47]
    v_and_b32 v48, v35, v16
    v_and_b32 v49, v35, v17
    v_and_b32 v50, v35, v18
    v_and_b32 v51, v35, v19
    v_mfma_f32_16x16x32_bf16 v[44:47], v[4:7], v[136:139], v[44:47]
    v_and_b32 v4, v36, v16
    v_and_b32 v5, v36, v17
    v_and_b32 v6, v36, v18
    v_and_b32 v7, v36, v19
    v_mfma_f32_16x16x32_bf16 v[44:47], v[48:51], v[140:143], v[44:47]
    v_and_b32 v48, v37, v16
    v_and_b32 v49, v37, v17
    v_and_b32 v50, v37, v18
    v_and_b32 v51, v37, v19
    v_mfma_f32_16x16x32_bf16 v[44:47], v[4:7], v[144:147], v[44:47]
    v_and_b32 v4, v38, v16
    v_and_b32 v5, v38, v17
    v_and_b32 v6, v38, v18
    v_and_b32 v7, v38, v19
    v_mfma_f32_16x16x32_bf16 v[44:47], v[48:51], v[148:151], v[44:47]
    v_and_b32 v48, v39, v16
    v_and_b32 v49, v39, v17
    v_and_b32 v50, v39, v18
    v_and_b32 v51, v39, v19
    v_mfma_f32_16x16x32_bf16 v[44:47], v[4:7], v[152:155], v[44:47]
    s_nop 0
    v_mfma_f32_16x16x32_bf16 v[44:47], v[48:51], v[156:159], v[44:47]
    s_mov_b64 exec, s[48:49]
    s_nop 6
    ds_write_b128 v56, v[44:47] offset:26624
    s_mov_b64 exec, -1
    s_waitcnt lgkmcnt(0)
    s_barrier
    s_cmp_lg_u32 s3, 0
    s_cbranch_scc1 L_exit
    s_mov_b64 exec, 0xffff
    ds_read_b128 v[24:27], v1 offset:26624
    ds_read_b128 v[28:31], v1 offset:26880
    ds_read_b128 v[32:35], v1 offset:27136
    ds_read_b128 v[36:39], v1 offset:27392
    ds_read_b128 v[40:43], v1 offset:27648
    ds_read_b128 v[44:47], v1 offset:27904
    ds_read_b128 v[48:51], v1 offset:28160
    ds_read_b128 v[52:55], v1 offset:28416
    s_waitcnt lgkmcnt(4)
    v_add_f32 v24, v24, v28
    v_add_f32 v32, v32, v36
    v_add_f32 v25, v25, v29
    v_add_f32 v33, v33, v37
    v_add_f32 v26, v26, v30
    v_add_f32 v34, v34, v38
    v_add_f32 v27, v27, v31
    v_add_f32 v35, v35, v39
    s_waitcnt lgkmcnt(0)
    v_add_f32 v40, v40, v44
    v_add_f32 v48, v48, v52
    v_add_f32 v41, v41, v45
    v_add_f32 v49, v49, v53
    v_add_f32 v42, v42, v46
    v_add_f32 v50, v50, v54
    v_add_f32 v43, v43, v47
    v_add_f32 v51, v51, v55
    v_add_f32 v24, v24, v32
    v_add_f32 v40, v40, v48
    v_add_f32 v25, v25, v33
    v_add_f32 v41, v41, v49
    v_add_f32 v26, v26, v34
    v_add_f32 v42, v42, v50
    v_add_f32 v27, v27, v35
    v_add_f32 v43, v43, v51
    v_add_f32 v24, v24, v40
    v_add_f32 v25, v25, v41
    v_add_f32 v26, v26, v42
    v_add_f32 v27, v27, v43
    v_min_u32 v24, -2, v24
    v_min_u32 v25, -2, v25
    v_min_u32 v26, -2, v26
    v_min_u32 v27, -2, v27
    global_store_dwordx4 v57, v[24:27], s[42:43] sc1
    s_mov_b64 exec, -1
    s_endpgm
L_s_idle:
L_exit:
L_end:
    s_endpgm
.section .rodata,"a"
.p2align 6
.amdhsa_kernel adaLN_cond__mha_block_cached__swiglu_ffn__decode_kernel
  .amdhsa_next_free_vgpr 168
  .amdhsa_next_free_sgpr 102
  .amdhsa_accum_offset 168
  .amdhsa_group_segment_fixed_size 0
  .amdhsa_kernarg_size 112
  .amdhsa_user_sgpr_count 2
  .amdhsa_user_sgpr_kernarg_segment_ptr 1
  .amdhsa_system_sgpr_workgroup_id_x 1
  .amdhsa_float_denorm_mode_32 3
.end_amdhsa_kernel
```
